```python
import torch

def _softmax(x, axis=-1):
    return torch.softmax(x, dim=axis)
def _gelu(x):
    return torch.nn.functional.gelu(x, approximate="tanh")
def _silu(x):
    return torch.nn.functional.silu(x)
def _sigmoid(x):
    return torch.sigmoid(x)
def _layernorm(x, axis=-1, eps=1e-5):
    m = x.mean(dim=axis, keepdim=True)
    v = x.var(dim=axis, keepdim=True, unbiased=False)
    return (x - m) / torch.sqrt(v + eps)
def _scatter_add(tgt, idx, src, axis=0):
    return tgt.clone().index_add_(axis, idx, src)
def _segment_sum(src, seg, n):
    out = torch.zeros((n,) + src.shape[1:], dtype=src.dtype)
    return out.index_add_(0, seg, src)
def _pad(x, pw):
    flat = tuple(v for pair in reversed(pw) for v in pair)
    return torch.nn.functional.pad(x, flat)

kernel_name = 'parallel_sum__gqa_block_cached__dense_activation_gelu__decode'

def setup_inputs():

    _w = (lambda a: (lambda t: t.to(torch.bfloat16) if t.is_floating_point() else t)(torch.as_tensor(a)))
    def _A_setup():
        B, Sq, D = 2, 1, 512
        Hq, Hkv, Sk, Dh = 32, 8, 8192, 128
        assert Hq % Hkv == 0, (Hq, Hkv)
        return {
            "x": _w((lambda *s: torch.randn(*s, dtype=torch.bfloat16) * 0.05)(B, Sq, D)),
            "k_cache": _w((lambda *s: torch.randn(*s, dtype=torch.bfloat16) * 1.6)(B, Hkv, Sk, Dh)),
            "v_cache": _w((lambda *s: torch.randn(*s, dtype=torch.bfloat16) * 0.8)(B, Hkv, Sk, Dh)),
            "wq": _w((lambda *s: torch.randn(*s, dtype=torch.bfloat16) * 1.6)(D, Hq * Dh) * (D ** -0.5)),
            "wo": _w((lambda *s: torch.randn(*s, dtype=torch.bfloat16) * 0.8)(Hq * Dh, D) * ((Hq * Dh) ** -0.5)),
        }
    _A_in = _A_setup()

    def _B_setup():
        B, S, D, F = 2, 1, 512, 1792
        return {
            "x": _w((lambda *s: torch.randn(*s, dtype=torch.bfloat16) * 0.05)(B, S, D)),
            "w1": _w((lambda *s: torch.randn(*s, dtype=torch.bfloat16) * 0.4)(D, F) * (D ** -0.5)),
            "b1": _w((lambda *s: torch.randn(*s, dtype=torch.bfloat16) * 0.4)(F) * 0.01),
            "w2": _w((lambda *s: torch.randn(*s, dtype=torch.bfloat16) * 0.4)(F, D) * (F ** -0.5)),
            "b2": _w((lambda *s: torch.randn(*s, dtype=torch.bfloat16) * 0.4)(D) * 0.01),
        }
    _B_in = _B_setup()

    return {
        "A_x": _A_in["x"],
        "A_k_cache": _A_in["k_cache"],
        "A_v_cache": _A_in["v_cache"],
        "A_wq": _A_in["wq"],
        "A_wo": _A_in["wo"],
        "B_x": _B_in["x"],
        "B_w1": _B_in["w1"],
        "B_b1": _B_in["b1"],
        "B_w2": _B_in["w2"],
        "B_b2": _B_in["b2"],
    }

def reference(A_x, A_k_cache, A_v_cache, A_wq, A_wo, B_x, B_w1, B_b1, B_w2, B_b2):
    def _A_ref(x, k_cache, v_cache, wq, wo):
        B, Sq, D = x.shape
        Hq, Dh = 32, 128
        Hkv = k_cache.shape[1]
        rep = Hq // Hkv
        q = (lambda x, *d: x.permute(*d))((x @ wq).reshape(B, Sq, Hq, Dh), 0, 2, 1, 3)
        k = (lambda x, n, axis: torch.repeat_interleave(x, n, dim=axis))(k_cache, rep, axis=1)
        v = (lambda x, n, axis: torch.repeat_interleave(x, n, dim=axis))(v_cache, rep, axis=1)
        scores = torch.einsum("bhqd,bhkd->bhqk", q, k) * (Dh ** -0.5)
        p = _softmax(scores, axis=-1)
        o = torch.einsum("bhqk,bhkd->bhqd", p, v)
        return (lambda x, *d: x.permute(*d))(o, 0, 2, 1, 3).reshape(B, Sq, Hq * Dh) @ wo

    def _B_ref(x, w1, b1, w2, b2):
        h = torch.einsum("bsd,df->bsf", x, w1) + b1
        h = _gelu(h)
        return torch.einsum("bsf,fd->bsd", h, w2) + b2

    x = A_x
    xn = _layernorm(x, axis=-1)
    return x + _A_ref(xn, A_k_cache, A_v_cache, A_wq, A_wo) + _B_ref(xn, B_w1, B_b1, B_w2, B_b2)
```

```asm
; @launch grid=(256,1,1) block=(768,1,1) lds=163840
.amdgcn_target "amdgcn-amd-amdhsa--gfx950"
.text
.globl parallel_sum__gqa_block_cached__dense_activation_gelu__decode_kernel
.p2align 8
.type parallel_sum__gqa_block_cached__dense_activation_gelu__decode_kernel,@function
parallel_sum__gqa_block_cached__dense_activation_gelu__decode_kernel:
    s_cmp_ge_u32 s2, 256
    s_cbranch_scc1 L_end
    s_load_dwordx16 s[4:19], s[0:1], 0
    s_load_dwordx8 s[20:27], s[0:1], 64
    s_load_dwordx2 s[28:29], s[0:1], 96
    v_lshrrev_b32 v1, 6, v0
    v_and_b32 v0, 63, v0
    s_add_u32 s31, s2, 0
    s_and_b32 s31, s31, 7
    v_readfirstlane_b32 s30, v1
    s_lshr_b32 s32, s2, 3
    s_cmp_eq_u32 s30, 0
    s_cbranch_scc0 L_nopre
    s_getpc_b64 s[40:41]
    v_lshlrev_b32 v5, 7, v0
    global_load_dword v164, v5, s[40:41]
    v_add_u32 v5, 0x2000, v5
    v_cmp_gt_u32 vcc, 40, v0
    s_and_saveexec_b64 s[42:43], vcc
    global_load_dword v165, v5, s[40:41]
    s_mov_b64 exec, s[42:43]
L_nopre:
    v_lshrrev_b32 v2, 4, v0
    v_and_b32 v3, 15, v0
    v_lshlrev_b32 v4, 4, v0
    s_waitcnt lgkmcnt(0)
    s_mov_b32 s36, s28
    s_mov_b32 s37, s29
    s_mov_b32 s38, 0x10000000
    s_mov_b32 s39, 0x20000
    s_lshr_b32 s88, s31, 2
    s_lshl_b32 s89, s31, 1
    s_lshr_b32 s90, s32, 4
    s_add_u32 s89, s89, s90
    s_and_b32 s89, s89, 7
    s_and_b32 s90, s32, 15
    s_add_u32 s35, s31, 1
    s_and_b32 s35, s35, 3
    s_lshl_b32 s35, s35, 1
    s_lshr_b32 s34, s31, 2
    s_add_u32 s35, s35, s34
    s_lshl_b32 s33, s89, 17
    s_lshl_b32 s34, s88, 11
    s_add_u32 s33, s33, s34
    s_add_u32 s33, s33, 1048576
    s_cmp_ge_u32 s30, 8
    s_cbranch_scc1 L_aux
    s_mov_b32 s40, s6
    s_mov_b32 s41, s7
    s_mov_b32 s42, 0x2000000
    s_mov_b32 s43, 0x20000
    s_mov_b32 s44, s8
    s_mov_b32 s45, s9
    s_mov_b32 s46, 0x2000000
    s_mov_b32 s47, 0x20000
    s_lshl_b32 s48, s31, 5
    s_add_u32 s48, s48, s32
    s_lshl_b32 s48, s48, 17
    s_lshl_b32 s49, s30, 10
    s_add_u32 s48, s48, s49
    s_lshl_b32 s49, s30, 14
    v_lshlrev_b32 v5, 2, v2
    v_lshlrev_b32 v6, 8, v2
    v_add_u32 v7, 0, v5
    v_xor_b32 v7, v7, v3
    v_lshl_add_u32 v140, v7, 4, v6
    v_add_u32 v7, 1, v5
    v_xor_b32 v7, v7, v3
    v_lshl_add_u32 v141, v7, 4, v6
    v_add_u32 v7, 2, v5
    v_xor_b32 v7, v7, v3
    v_lshl_add_u32 v142, v7, 4, v6
    v_add_u32 v7, 3, v5
    v_xor_b32 v7, v7, v3
    v_lshl_add_u32 v143, v7, 4, v6
    s_barrier
    s_add_u32 m0, s49, 0
    s_add_u32 s50, s48, 0
    buffer_load_dwordx4 v140, s[40:43], s50 offen nt lds
    s_add_u32 m0, s49, 1024
    s_add_u32 s50, s48, 8192
    buffer_load_dwordx4 v141, s[40:43], s50 offen nt lds
    s_add_u32 m0, s49, 2048
    s_add_u32 s50, s48, 16384
    buffer_load_dwordx4 v142, s[40:43], s50 offen nt lds
    s_add_u32 m0, s49, 3072
    s_add_u32 s50, s48, 24576
    buffer_load_dwordx4 v143, s[40:43], s50 offen nt lds
    s_load_dwordx2 s[80:81], s[28:29], 262144
    v_lshrrev_b32 v5, 2, v3
    v_lshlrev_b32 v5, 8, v5
    v_lshl_add_u32 v5, v2, 4, v5
    v_add_u32 v158, 159744, v5
    v_and_b32 v5, 3, v3
    v_lshlrev_b32 v5, 2, v5
    v_lshrrev_b32 v6, 2, v3
    v_add_u32 v5, v5, v6
    v_lshlrev_b32 v5, 8, v5
    v_add_u32 v5, s49, v5
    v_or_b32 v6, 0, v2
    v_xor_b32 v6, v6, v3
    v_lshl_add_u32 v144, v6, 4, v5
    v_or_b32 v6, 4, v2
    v_xor_b32 v6, v6, v3
    v_lshl_add_u32 v145, v6, 4, v5
    v_or_b32 v6, 8, v2
    v_xor_b32 v6, v6, v3
    v_lshl_add_u32 v146, v6, 4, v5
    v_or_b32 v6, 12, v2
    v_xor_b32 v6, v6, v3
    v_lshl_add_u32 v147, v6, 4, v5
    s_mov_b32 s56, 0x05040100
    s_mov_b32 s57, 0x07060302
    v_mov_b32 v153, 0xfffff000
    v_lshlrev_b32 v5, 9, v2
    v_lshl_add_u32 v5, v3, 5, v5
    v_add_u32 v154, s49, v5
    s_mov_b32 s52, 0x3fb8aa3b
    v_and_b32 v148, 0x33, v0
    v_lshrrev_b32 v5, 3, v0
    s_lshl_b32 s53, s30, 3
    v_add_u32 v5, s53, v5
    v_and_b32 v6, 7, v0
    v_lshlrev_b32 v7, 6, v5
    v_lshl_add_u32 v7, v6, 4, v7
    s_lshl_b32 s53, s30, 4
    s_add_u32 s53, s53, 2048
    v_mov_b32 v156, s53
    v_cmp_gt_u32 vcc, 4, v6
    v_add_u32 v157, s90, v5
    v_and_b32 v157, 15, v157
    v_lshlrev_b32 v157, 7, v157
    v_cndmask_b32 v156, v156, v7, vcc
    v_lshl_add_u32 v157, v5, 12, v157
    v_lshl_add_u32 v157, v6, 4, v157
    s_waitcnt vmcnt(3)
    s_add_u32 m0, s49, 4096
    s_add_u32 s50, s48, 32768
    buffer_load_dwordx4 v140, s[40:43], s50 offen nt lds
    s_waitcnt vmcnt(3)
    s_add_u32 m0, s49, 5120
    s_add_u32 s50, s48, 40960
    buffer_load_dwordx4 v141, s[40:43], s50 offen nt lds
    s_waitcnt vmcnt(3)
    s_add_u32 m0, s49, 6144
    s_add_u32 s50, s48, 49152
    buffer_load_dwordx4 v142, s[40:43], s50 offen nt lds
    s_waitcnt vmcnt(3)
    s_add_u32 m0, s49, 7168
    s_add_u32 s50, s48, 57344
    buffer_load_dwordx4 v143, s[40:43], s50 offen nt lds
    s_waitcnt vmcnt(3)
    s_add_u32 m0, s49, 8192
    s_add_u32 s50, s48, 65536
    buffer_load_dwordx4 v140, s[40:43], s50 offen nt lds
    s_waitcnt vmcnt(3)
    s_add_u32 m0, s49, 9216
    s_add_u32 s50, s48, 73728
    buffer_load_dwordx4 v141, s[40:43], s50 offen nt lds
    s_waitcnt vmcnt(3)
    s_add_u32 m0, s49, 10240
    s_add_u32 s50, s48, 81920
    buffer_load_dwordx4 v142, s[40:43], s50 offen nt lds
    s_waitcnt vmcnt(3)
    s_add_u32 m0, s49, 11264
    s_add_u32 s50, s48, 90112
    buffer_load_dwordx4 v143, s[40:43], s50 offen nt lds
    s_waitcnt vmcnt(3)
    s_add_u32 m0, s49, 12288
    s_add_u32 s50, s48, 98304
    buffer_load_dwordx4 v140, s[40:43], s50 offen nt lds
    s_waitcnt vmcnt(3)
    s_add_u32 m0, s49, 13312
    s_add_u32 s50, s48, 106496
    buffer_load_dwordx4 v141, s[40:43], s50 offen nt lds
    s_waitcnt vmcnt(3)
    s_add_u32 m0, s49, 14336
    s_add_u32 s50, s48, 114688
    buffer_load_dwordx4 v142, s[40:43], s50 offen nt lds
    s_waitcnt vmcnt(3)
    s_add_u32 m0, s49, 15360
    s_add_u32 s50, s48, 122880
    buffer_load_dwordx4 v143, s[40:43], s50 offen nt lds
    s_waitcnt vmcnt(3)
    s_add_u32 s50, s48, 0
    buffer_load_dwordx4 v[8:11], v4, s[44:47], s50 offen nt
    s_waitcnt vmcnt(3)
    s_add_u32 s50, s48, 8192
    buffer_load_dwordx4 v[12:15], v4, s[44:47], s50 offen nt
    s_waitcnt vmcnt(3)
    s_add_u32 s50, s48, 16384
    buffer_load_dwordx4 v[16:19], v4, s[44:47], s50 offen nt
    s_waitcnt vmcnt(3)
    s_add_u32 s50, s48, 24576
    buffer_load_dwordx4 v[20:23], v4, s[44:47], s50 offen nt
    s_waitcnt vmcnt(3)
    s_add_u32 s50, s48, 32768
    buffer_load_dwordx4 v[24:27], v4, s[44:47], s50 offen nt
    s_waitcnt vmcnt(3)
    s_add_u32 s50, s48, 40960
    buffer_load_dwordx4 v[28:31], v4, s[44:47], s50 offen nt
    s_waitcnt vmcnt(3)
    s_add_u32 s50, s48, 49152
    buffer_load_dwordx4 v[32:35], v4, s[44:47], s50 offen nt
    s_waitcnt vmcnt(3)
    s_add_u32 s50, s48, 57344
    buffer_load_dwordx4 v[36:39], v4, s[44:47], s50 offen nt
    v_mov_b32 v5, 161536
L_bq:
    ds_read_b32 v6, v5
    s_waitcnt lgkmcnt(0)
    v_readfirstlane_b32 s51, v6
    s_cmp_eq_u32 s51, 0
    s_cbranch_scc0 L_bq_d
    s_sleep 2
    s_branch L_bq
L_bq_d:
    ds_read_b128 v[88:91], v158 offset:0
    ds_read_b128 v[92:95], v158 offset:64
    ds_read_b128 v[96:99], v158 offset:128
    ds_read_b128 v[100:103], v158 offset:192
    s_waitcnt vmcnt(4)
    ds_read_b128 v[72:75], v144 offset:0
    ds_read_b128 v[76:79], v145 offset:0
    ds_read_b128 v[80:83], v146 offset:0
    ds_read_b128 v[84:87], v147 offset:0
    s_waitcnt lgkmcnt(3)
    v_mfma_f32_16x16x32_bf16 v[104:107], v[72:75], v[88:91], 0
    s_waitcnt lgkmcnt(2)
    v_mfma_f32_16x16x32_bf16 v[104:107], v[76:79], v[92:95], v[104:107]
    s_waitcnt lgkmcnt(1)
    v_mfma_f32_16x16x32_bf16 v[104:107], v[80:83], v[96:99], v[104:107]
    s_waitcnt lgkmcnt(0)
    v_mfma_f32_16x16x32_bf16 v[104:107], v[84:87], v[100:103], v[104:107]
    ds_read_b128 v[72:75], v144 offset:4096
    ds_read_b128 v[76:79], v145 offset:4096
    ds_read_b128 v[80:83], v146 offset:4096
    ds_read_b128 v[84:87], v147 offset:4096
    s_waitcnt lgkmcnt(3)
    v_mfma_f32_16x16x32_bf16 v[108:111], v[72:75], v[88:91], 0
    s_waitcnt lgkmcnt(2)
    v_mfma_f32_16x16x32_bf16 v[108:111], v[76:79], v[92:95], v[108:111]
    s_waitcnt lgkmcnt(1)
    v_mfma_f32_16x16x32_bf16 v[108:111], v[80:83], v[96:99], v[108:111]
    s_waitcnt lgkmcnt(0)
    v_mfma_f32_16x16x32_bf16 v[108:111], v[84:87], v[100:103], v[108:111]
    ds_read_b128 v[72:75], v144 offset:8192
    ds_read_b128 v[76:79], v145 offset:8192
    ds_read_b128 v[80:83], v146 offset:8192
    ds_read_b128 v[84:87], v147 offset:8192
    s_waitcnt lgkmcnt(3)
    v_mfma_f32_16x16x32_bf16 v[112:115], v[72:75], v[88:91], 0
    s_waitcnt lgkmcnt(2)
    v_mfma_f32_16x16x32_bf16 v[112:115], v[76:79], v[92:95], v[112:115]
    s_waitcnt lgkmcnt(1)
    v_mfma_f32_16x16x32_bf16 v[112:115], v[80:83], v[96:99], v[112:115]
    s_waitcnt lgkmcnt(0)
    v_mfma_f32_16x16x32_bf16 v[112:115], v[84:87], v[100:103], v[112:115]
    ds_read_b128 v[72:75], v144 offset:12288
    ds_read_b128 v[76:79], v145 offset:12288
    ds_read_b128 v[80:83], v146 offset:12288
    ds_read_b128 v[84:87], v147 offset:12288
    s_waitcnt lgkmcnt(3)
    v_mfma_f32_16x16x32_bf16 v[116:119], v[72:75], v[88:91], 0
    s_waitcnt lgkmcnt(2)
    v_mfma_f32_16x16x32_bf16 v[116:119], v[76:79], v[92:95], v[116:119]
    s_waitcnt lgkmcnt(1)
    v_mfma_f32_16x16x32_bf16 v[116:119], v[80:83], v[96:99], v[116:119]
    s_waitcnt lgkmcnt(0)
    v_mfma_f32_16x16x32_bf16 v[116:119], v[84:87], v[100:103], v[116:119]
    s_nop 7
    s_nop 1
    s_mov_b32 s60, 0x3db504f3
    s_mov_b32 s61, s60
    v_cvt_pk_bf16_f32 v128, v104, v105
    v_cvt_pk_bf16_f32 v129, v106, v107
    v_cvt_pk_bf16_f32 v130, v108, v109
    v_cvt_pk_bf16_f32 v131, v110, v111
    v_cvt_pk_bf16_f32 v132, v112, v113
    v_cvt_pk_bf16_f32 v133, v114, v115
    v_cvt_pk_bf16_f32 v134, v116, v117
    v_cvt_pk_bf16_f32 v135, v118, v119
    v_lshlrev_b32 v104, 16, v128
    v_and_b32 v105, 0xffff0000, v128
    v_lshlrev_b32 v106, 16, v129
    v_and_b32 v107, 0xffff0000, v129
    v_lshlrev_b32 v108, 16, v130
    v_and_b32 v109, 0xffff0000, v130
    v_lshlrev_b32 v110, 16, v131
    v_and_b32 v111, 0xffff0000, v131
    v_lshlrev_b32 v112, 16, v132
    v_and_b32 v113, 0xffff0000, v132
    v_lshlrev_b32 v114, 16, v133
    v_and_b32 v115, 0xffff0000, v133
    v_lshlrev_b32 v116, 16, v134
    v_and_b32 v117, 0xffff0000, v134
    v_lshlrev_b32 v118, 16, v135
    v_and_b32 v119, 0xffff0000, v135
    v_pk_mul_f32 v[104:105], v[104:105], s[60:61]
    v_pk_mul_f32 v[106:107], v[106:107], s[60:61]
    v_pk_mul_f32 v[108:109], v[108:109], s[60:61]
    v_pk_mul_f32 v[110:111], v[110:111], s[60:61]
    v_pk_mul_f32 v[112:113], v[112:113], s[60:61]
    v_pk_mul_f32 v[114:115], v[114:115], s[60:61]
    v_pk_mul_f32 v[116:117], v[116:117], s[60:61]
    v_pk_mul_f32 v[118:119], v[118:119], s[60:61]
    v_cvt_pk_bf16_f32 v128, v104, v105
    v_cvt_pk_bf16_f32 v129, v106, v107
    v_cvt_pk_bf16_f32 v130, v108, v109
    v_cvt_pk_bf16_f32 v131, v110, v111
    v_cvt_pk_bf16_f32 v132, v112, v113
    v_cvt_pk_bf16_f32 v133, v114, v115
    v_cvt_pk_bf16_f32 v134, v116, v117
    v_cvt_pk_bf16_f32 v135, v118, v119
    v_lshlrev_b32 v104, 16, v128
    v_and_b32 v105, 0xffff0000, v128
    v_lshlrev_b32 v106, 16, v129
    v_and_b32 v107, 0xffff0000, v129
    v_lshlrev_b32 v108, 16, v130
    v_and_b32 v109, 0xffff0000, v130
    v_lshlrev_b32 v110, 16, v131
    v_and_b32 v111, 0xffff0000, v131
    v_lshlrev_b32 v112, 16, v132
    v_and_b32 v113, 0xffff0000, v132
    v_lshlrev_b32 v114, 16, v133
    v_and_b32 v115, 0xffff0000, v133
    v_lshlrev_b32 v116, 16, v134
    v_and_b32 v117, 0xffff0000, v134
    v_lshlrev_b32 v118, 16, v135
    v_and_b32 v119, 0xffff0000, v135
    v_max3_f32 v5, v104, v105, v106
    v_max3_f32 v5, v5, v107, v108
    v_max3_f32 v5, v5, v109, v110
    v_max3_f32 v5, v5, v111, v112
    v_max3_f32 v5, v5, v113, v114
    v_max3_f32 v5, v5, v115, v116
    v_max3_f32 v5, v5, v117, v118
    v_max_f32 v5, v5, v119
    v_mov_b32 v6, v5
    v_mov_b32 v7, v5
    s_nop 1
    v_permlane16_swap_b32 v6, v7
    s_nop 0
    v_max_f32 v5, v6, v7
    v_mov_b32 v6, v5
    v_mov_b32 v7, v5
    s_nop 1
    v_permlane32_swap_b32 v6, v7
    s_nop 0
    v_max_f32 v5, v6, v7
    v_mul_f32 v151, s52, v5
    v_lshrrev_b32 v6, 2, v3
    v_lshlrev_b32 v6, 5, v6
    s_lshl_b32 s53, s30, 2
    s_add_u32 s53, s53, 161280
    v_add_u32 v7, s53, v6
    v_cmp_eq_u32 vcc, 0, v148
    s_and_saveexec_b64 s[54:55], vcc
    ds_write_b32 v7, v151
    s_mov_b64 exec, s[54:55]
    v_mov_b32 v149, 161544
    v_mov_b32 v150, 1
    v_cmp_eq_u32 vcc, 0, v0
    s_and_saveexec_b64 s[54:55], vcc
    ds_add_u32 v149, v150
    s_mov_b64 exec, s[54:55]
    v_fma_f32 v104, v104, s52, -v151
    v_fma_f32 v105, v105, s52, -v151
    v_fma_f32 v106, v106, s52, -v151
    v_fma_f32 v107, v107, s52, -v151
    v_fma_f32 v108, v108, s52, -v151
    v_fma_f32 v109, v109, s52, -v151
    v_fma_f32 v110, v110, s52, -v151
    v_fma_f32 v111, v111, s52, -v151
    v_fma_f32 v112, v112, s52, -v151
    v_fma_f32 v113, v113, s52, -v151
    v_fma_f32 v114, v114, s52, -v151
    v_fma_f32 v115, v115, s52, -v151
    v_fma_f32 v116, v116, s52, -v151
    v_fma_f32 v117, v117, s52, -v151
    v_fma_f32 v118, v118, s52, -v151
    v_fma_f32 v119, v119, s52, -v151
    v_exp_f32 v104, v104
    v_exp_f32 v105, v105
    v_exp_f32 v106, v106
    v_exp_f32 v107, v107
    v_exp_f32 v108, v108
    v_exp_f32 v109, v109
    v_exp_f32 v110, v110
    v_exp_f32 v111, v111
    v_exp_f32 v112, v112
    v_exp_f32 v113, v113
    v_exp_f32 v114, v114
    v_exp_f32 v115, v115
    v_exp_f32 v116, v116
    v_exp_f32 v117, v117
    v_exp_f32 v118, v118
    v_exp_f32 v119, v119
    s_nop 0
    v_add_f32 v152, v104, v105
    v_add_f32 v152, v152, v106
    v_add_f32 v152, v152, v107
    v_add_f32 v152, v152, v108
    v_add_f32 v152, v152, v109
    v_add_f32 v152, v152, v110
    v_add_f32 v152, v152, v111
    v_add_f32 v152, v152, v112
    v_add_f32 v152, v152, v113
    v_add_f32 v152, v152, v114
    v_add_f32 v152, v152, v115
    v_add_f32 v152, v152, v116
    v_add_f32 v152, v152, v117
    v_add_f32 v152, v152, v118
    v_add_f32 v152, v152, v119
    v_cvt_pk_bf16_f32 v120, v104, v105
    v_cvt_pk_bf16_f32 v121, v106, v107
    v_cvt_pk_bf16_f32 v122, v108, v109
    v_cvt_pk_bf16_f32 v123, v110, v111
    v_cvt_pk_bf16_f32 v124, v112, v113
    v_cvt_pk_bf16_f32 v125, v114, v115
    v_cvt_pk_bf16_f32 v126, v116, v117
    v_cvt_pk_bf16_f32 v127, v118, v119
    v_mov_b32 v6, v152
    v_mov_b32 v7, v152
    s_nop 1
    v_permlane16_swap_b32 v6, v7
    s_nop 0
    v_add_f32 v152, v6, v7
    v_mov_b32 v6, v152
    v_mov_b32 v7, v152
    s_nop 1
    v_permlane32_swap_b32 v6, v7
    s_nop 0
    v_add_f32 v152, v6, v7
    s_waitcnt lgkmcnt(0)
    s_add_u32 s82, s80, 1
    s_addc_u32 s83, s81, 0
    s_and_b32 s84, s82, 0xfff
    s_bfe_u32 s85, s82, 0xc000c
    s_lshr_b32 s86, s82, 24
    s_lshl_b32 s87, s83, 8
    s_or_b32 s86, s86, s87
    s_and_b32 s86, s86, 0xfff
    s_bfe_u32 s87, s83, 0xc0004
    s_waitcnt vmcnt(3)
    s_add_u32 s50, s48, 65536
    buffer_load_dwordx4 v[40:43], v4, s[44:47], s50 offen nt
    s_waitcnt vmcnt(3)
    s_add_u32 s50, s48, 73728
    buffer_load_dwordx4 v[44:47], v4, s[44:47], s50 offen nt
    s_waitcnt vmcnt(3)
    s_add_u32 s50, s48, 81920
    buffer_load_dwordx4 v[48:51], v4, s[44:47], s50 offen nt
    s_waitcnt vmcnt(3)
    s_add_u32 s50, s48, 90112
    buffer_load_dwordx4 v[52:55], v4, s[44:47], s50 offen nt
    s_waitcnt vmcnt(4)
    v_perm_b32 v128, v12, v8, s56
    v_perm_b32 v129, v20, v16, s56
    v_perm_b32 v130, v28, v24, s56
    v_perm_b32 v131, v36, v32, s56
    s_nop 1
    v_mfma_f32_16x16x32_bf16 v[72:75], v[120:123], v[128:131], 0
    v_perm_b32 v132, v12, v8, s57
    v_perm_b32 v133, v20, v16, s57
    v_perm_b32 v134, v28, v24, s57
    v_perm_b32 v135, v36, v32, s57
    s_nop 1
    v_mfma_f32_16x16x32_bf16 v[76:79], v[120:123], v[132:135], 0
    v_perm_b32 v128, v13, v9, s56
    v_perm_b32 v129, v21, v17, s56
    v_perm_b32 v130, v29, v25, s56
    v_perm_b32 v131, v37, v33, s56
    s_nop 1
    v_mfma_f32_16x16x32_bf16 v[80:83], v[120:123], v[128:131], 0
    v_perm_b32 v132, v13, v9, s57
    v_perm_b32 v133, v21, v17, s57
    v_perm_b32 v134, v29, v25, s57
    v_perm_b32 v135, v37, v33, s57
    s_nop 1
    v_mfma_f32_16x16x32_bf16 v[84:87], v[120:123], v[132:135], 0
    v_perm_b32 v128, v14, v10, s56
    v_perm_b32 v129, v22, v18, s56
    v_perm_b32 v130, v30, v26, s56
    v_perm_b32 v131, v38, v34, s56
    s_nop 1
    v_mfma_f32_16x16x32_bf16 v[88:91], v[120:123], v[128:131], 0
    v_perm_b32 v132, v14, v10, s57
    v_perm_b32 v133, v22, v18, s57
    v_perm_b32 v134, v30, v26, s57
    v_perm_b32 v135, v38, v34, s57
    s_nop 1
    v_mfma_f32_16x16x32_bf16 v[92:95], v[120:123], v[132:135], 0
    v_perm_b32 v128, v15, v11, s56
    v_perm_b32 v129, v23, v19, s56
    v_perm_b32 v130, v31, v27, s56
    v_perm_b32 v131, v39, v35, s56
    s_nop 1
    v_mfma_f32_16x16x32_bf16 v[96:99], v[120:123], v[128:131], 0
    v_perm_b32 v132, v15, v11, s57
    v_perm_b32 v133, v23, v19, s57
    v_perm_b32 v134, v31, v27, s57
    v_perm_b32 v135, v39, v35, s57
    s_nop 1
    v_mfma_f32_16x16x32_bf16 v[100:103], v[120:123], v[132:135], 0
    s_waitcnt vmcnt(3)
    s_add_u32 s50, s48, 98304
    buffer_load_dwordx4 v[56:59], v4, s[44:47], s50 offen nt
    s_waitcnt vmcnt(3)
    s_add_u32 s50, s48, 106496
    buffer_load_dwordx4 v[60:63], v4, s[44:47], s50 offen nt
    s_waitcnt vmcnt(3)
    s_add_u32 s50, s48, 114688
    buffer_load_dwordx4 v[64:67], v4, s[44:47], s50 offen nt
    s_waitcnt vmcnt(3)
    s_add_u32 s50, s48, 122880
    buffer_load_dwordx4 v[68:71], v4, s[44:47], s50 offen nt
    s_cmp_eq_u32 s30, 0
    s_cbranch_scc0 L_nowt
    v_mov_b32 v5, 161560
    v_mov_b32 v6, 1
    ds_write_b32 v5, v6
L_nowt:
    v_mov_b32 v149, 161544
L_bm:
    ds_read_b32 v150, v149
    s_waitcnt lgkmcnt(0)
    v_readfirstlane_b32 s51, v150
    s_cmp_lt_u32 s51, 8
    s_cbranch_scc0 L_bm_d
    s_sleep 1
    s_branch L_bm
L_bm_d:
    v_lshrrev_b32 v6, 2, v3
    v_lshlrev_b32 v6, 5, v6
    v_add_u32 v7, 161280, v6
    ds_read_b128 v[104:107], v7
    ds_read_b128 v[108:111], v7 offset:16
    s_waitcnt lgkmcnt(0)
    v_max3_f32 v5, v104, v105, v106
    v_max3_f32 v5, v5, v107, v108
    v_max3_f32 v5, v5, v109, v110
    v_max_f32 v5, v5, v111
    v_and_b32 v5, 0xfffff000, v5
    v_sub_f32 v155, v151, v5
    v_exp_f32 v155, v155
    v_mul_f32 v128, 0x3e000000, v5
    v_mov_b32 v130, 0
    v_mov_b32 v131, 0
    v_mul_f32 v129, v152, v155
    v_lshrrev_b32 v6, 2, v3
    v_lshlrev_b32 v6, 4, v6
    s_add_u32 s53, s49, 2048
    v_add_u32 v7, s53, v6
    v_cmp_eq_u32 vcc, 0, v148
    s_and_saveexec_b64 s[54:55], vcc
    ds_write_b128 v7, v[128:131]
    s_mov_b64 exec, s[54:55]
    v_lshlrev_b32 v7, 5, v2
    v_add_u32 v7, 161280, v7
    s_lshl_b32 s53, s30, 2
    v_add_u32 v6, s53, v7
    ds_read_b128 v[104:107], v7
    ds_read_b128 v[108:111], v7 offset:16
    ds_read_b32 v155, v6
    s_waitcnt lgkmcnt(0)
    v_max3_f32 v5, v104, v105, v106
    v_max3_f32 v5, v5, v107, v108
    v_max3_f32 v5, v5, v109, v110
    v_max_f32 v5, v5, v111
    v_and_b32 v5, 0xfffff000, v5
    v_sub_f32 v155, v155, v5
    v_exp_f32 v155, v155
    s_waitcnt vmcnt(6)
    v_perm_b32 v8, v44, v40, s56
    v_perm_b32 v12, v44, v40, s57
    v_perm_b32 v16, v45, v41, s56
    v_perm_b32 v20, v45, v41, s57
    v_perm_b32 v24, v46, v42, s56
    v_perm_b32 v28, v46, v42, s57
    v_perm_b32 v32, v47, v43, s56
    v_perm_b32 v36, v47, v43, s57
    s_waitcnt vmcnt(4)
    v_perm_b32 v9, v52, v48, s56
    v_perm_b32 v13, v52, v48, s57
    v_perm_b32 v17, v53, v49, s56
    v_perm_b32 v21, v53, v49, s57
    v_perm_b32 v25, v54, v50, s56
    v_perm_b32 v29, v54, v50, s57
    v_perm_b32 v33, v55, v51, s56
    v_perm_b32 v37, v55, v51, s57
    s_waitcnt vmcnt(2)
    v_perm_b32 v10, v60, v56, s56
    v_perm_b32 v14, v60, v56, s57
    v_perm_b32 v18, v61, v57, s56
    v_perm_b32 v22, v61, v57, s57
    v_perm_b32 v26, v62, v58, s56
    v_perm_b32 v30, v62, v58, s57
    v_perm_b32 v34, v63, v59, s56
    v_perm_b32 v38, v63, v59, s57
    s_waitcnt vmcnt(0)
    v_perm_b32 v11, v68, v64, s56
    v_perm_b32 v15, v68, v64, s57
    v_perm_b32 v19, v69, v65, s56
    v_mfma_f32_16x16x32_bf16 v[72:75], v[124:127], v[8:11], v[72:75]
    v_perm_b32 v23, v69, v65, s57
    v_mfma_f32_16x16x32_bf16 v[76:79], v[124:127], v[12:15], v[76:79]
    v_perm_b32 v27, v70, v66, s56
    v_mfma_f32_16x16x32_bf16 v[80:83], v[124:127], v[16:19], v[80:83]
    v_perm_b32 v31, v70, v66, s57
    v_mfma_f32_16x16x32_bf16 v[84:87], v[124:127], v[20:23], v[84:87]
    v_perm_b32 v35, v71, v67, s56
    v_mfma_f32_16x16x32_bf16 v[88:91], v[124:127], v[24:27], v[88:91]
    v_perm_b32 v39, v71, v67, s57
    v_mfma_f32_16x16x32_bf16 v[92:95], v[124:127], v[28:31], v[92:95]
    s_nop 0
    v_mfma_f32_16x16x32_bf16 v[96:99], v[124:127], v[32:35], v[96:99]
    v_mfma_f32_16x16x32_bf16 v[100:103], v[124:127], v[36:39], v[100:103]
    s_nop 3
    v_mul_f32 v104, v72, v155
    v_mul_f32 v105, v76, v155
    v_mul_f32 v106, v80, v155
    v_mul_f32 v107, v84, v155
    v_mul_f32 v108, v88, v155
    v_mul_f32 v109, v92, v155
    s_nop 3
    v_mul_f32 v110, v96, v155
    v_mul_f32 v111, v100, v155
    ds_write_b128 v154, v[104:107]
    ds_write_b128 v154, v[108:111] offset:16
    s_waitcnt lgkmcnt(0)
    s_barrier
    s_cmp_ge_u32 s30, 4
    s_cbranch_scc1 L_bpub_done
    v_add_u32 v6, 0x10000, v156
    ds_read_b128 v[72:75], v156 offset:0
    ds_read_b128 v[76:79], v156 offset:16384
    ds_read_b128 v[80:83], v156 offset:32768
    ds_read_b128 v[84:87], v156 offset:49152
    ds_read_b128 v[88:91], v6 offset:0
    ds_read_b128 v[92:95], v6 offset:16384
    ds_read_b128 v[96:99], v6 offset:32768
    ds_read_b128 v[100:103], v6 offset:49152
    s_waitcnt lgkmcnt(4)
    v_pk_add_f32 v[72:73], v[72:73], v[76:77]
    v_pk_add_f32 v[80:81], v[80:81], v[84:85]
    v_pk_add_f32 v[74:75], v[74:75], v[78:79]
    v_pk_add_f32 v[82:83], v[82:83], v[86:87]
    s_waitcnt lgkmcnt(0)
    v_pk_add_f32 v[88:89], v[88:89], v[92:93]
    v_pk_add_f32 v[96:97], v[96:97], v[100:101]
    v_pk_add_f32 v[90:91], v[90:91], v[94:95]
    v_pk_add_f32 v[98:99], v[98:99], v[102:103]
    v_pk_add_f32 v[72:73], v[72:73], v[80:81]
    v_pk_add_f32 v[88:89], v[88:89], v[96:97]
    v_pk_add_f32 v[74:75], v[74:75], v[82:83]
    v_pk_add_f32 v[90:91], v[90:91], v[98:99]
    v_pk_add_f32 v[72:73], v[72:73], v[88:89]
    v_pk_add_f32 v[74:75], v[74:75], v[90:91]
    v_and_or_b32 v72, v72, v153, s84
    v_and_or_b32 v73, v73, v153, s85
    v_and_or_b32 v74, v74, v153, s86
    v_and_or_b32 v75, v75, v153, s87
    buffer_store_dwordx4 v[72:75], v157, s[36:39], s33 offen sc1
L_bpub_done:
    s_cmp_ge_u32 s2, 32
    s_cbranch_scc1 L_fin
    s_lshl_b32 s58, s30, 12
    s_lshl_b32 s59, s2, 15
    s_add_u32 s58, s58, s59
    s_add_u32 s58, s58, 2097152
    s_mov_b32 s68, s24
    s_mov_b32 s69, s25
    s_mov_b32 s70, 2048
    s_mov_b32 s71, 0x20000
    s_lshl_b32 s59, s2, 6
    v_and_b32 v8, 31, v0
    v_lshlrev_b32 v8, 1, v8
    v_mov_b32 v6, 161556
L_by:
    ds_read_b32 v7, v6
    s_waitcnt lgkmcnt(0)
    v_readfirstlane_b32 s51, v7
    s_cmp_eq_u32 s51, 0
    s_cbranch_scc0 L_by_d
    s_sleep 1
    s_branch L_by
L_by_d:
    s_cmp_eq_u32 s30, 0
    s_cbranch_scc0 L_l2
    s_mov_b32 s60, s4
    s_mov_b32 s61, s5
    s_mov_b32 s62, 2048
    s_mov_b32 s63, 0x20000
    s_mov_b32 s64, s22
    s_mov_b32 s65, s23
    s_mov_b32 s66, 1024
    s_mov_b32 s67, 0x20000
    s_and_b32 s72, s59, 1023
    buffer_load_ushort v9, v8, s[60:63], s59 offen
    buffer_load_ushort v10, v8, s[64:67], s72 offen
L_l2:
    buffer_load_dwordx4 v[72:75], v4, s[36:39], s58 offen offset:0 sc1
    buffer_load_dwordx4 v[76:79], v4, s[36:39], s58 offen offset:1024 sc1
    buffer_load_dwordx4 v[80:83], v4, s[36:39], s58 offen offset:2048 sc1
    buffer_load_dwordx4 v[84:87], v4, s[36:39], s58 offen offset:3072 sc1
    s_waitcnt vmcnt(0)
    v_xor_b32 v72, s84, v72
    v_xor_b32 v73, s85, v73
    v_xor_b32 v74, s86, v74
    v_xor_b32 v75, s87, v75
    v_xor_b32 v76, s84, v76
    v_xor_b32 v77, s85, v77
    v_xor_b32 v78, s86, v78
    v_xor_b32 v79, s87, v79
    v_xor_b32 v80, s84, v80
    v_xor_b32 v81, s85, v81
    v_xor_b32 v82, s86, v82
    v_xor_b32 v83, s87, v83
    v_xor_b32 v84, s84, v84
    v_xor_b32 v85, s85, v85
    v_xor_b32 v86, s86, v86
    v_xor_b32 v87, s87, v87
    v_or3_b32 v7, v72, v73, v74
    v_or3_b32 v7, v7, v75, v76
    v_or3_b32 v7, v7, v77, v78
    v_or3_b32 v7, v7, v79, v80
    v_or3_b32 v7, v7, v81, v82
    v_or3_b32 v7, v7, v83, v84
    v_or3_b32 v7, v7, v85, v86
    v_or_b32 v7, v7, v87
    v_and_b32 v7, 0xfff, v7
    v_cmp_ne_u32 vcc, 0, v7
    s_cbranch_vccz L_l2_done
    s_sleep 1
    s_branch L_l2
L_l2_done:
    v_add_f32 v72, v72, v76
    v_add_f32 v80, v80, v84
    v_add_f32 v73, v73, v77
    v_add_f32 v81, v81, v85
    v_add_f32 v74, v74, v78
    v_add_f32 v82, v82, v86
    v_add_f32 v75, v75, v79
    v_add_f32 v83, v83, v87
    v_add_f32 v72, v72, v80
    v_add_f32 v73, v73, v81
    v_add_f32 v74, v74, v82
    v_add_f32 v75, v75, v83
    s_nop 0
    v_add_f32_dpp v72, v72, v72 row_ror:8 row_mask:0xf bank_mask:0xf
    v_add_f32_dpp v73, v73, v73 row_ror:8 row_mask:0xf bank_mask:0xf
    v_add_f32_dpp v74, v74, v74 row_ror:8 row_mask:0xf bank_mask:0xf
    v_add_f32_dpp v75, v75, v75 row_ror:8 row_mask:0xf bank_mask:0xf
    s_lshl_b32 s73, s30, 7
    s_add_u32 s73, s73, 162304
    v_permlane16_swap_b32 v72, v73
    v_permlane16_swap_b32 v74, v75
    v_and_b32 v6, 7, v0
    v_lshlrev_b32 v6, 4, v6
    v_add_f32 v72, v72, v73
    v_add_f32 v74, v74, v75
    v_lshl_add_u32 v6, v2, 2, v6
    s_nop 0
    v_permlane32_swap_b32 v72, v74
    v_add_u32 v6, s73, v6
    v_add_f32 v72, v72, v74
    v_and_b32 v7, 8, v0
    v_cmp_eq_u32 vcc, 0, v7
    s_and_saveexec_b64 s[54:55], vcc
    ds_write_b32 v6, v72
    s_mov_b64 exec, s[54:55]
    s_waitcnt lgkmcnt(0)
    s_barrier
    s_cmp_eq_u32 s30, 0
    s_cbranch_scc0 L_fin
    v_and_b32 v6, 31, v0
    v_lshlrev_b32 v6, 2, v6
    v_add_u32 v6, 162304, v6
    ds_read_b32 v72, v6 offset:0
    ds_read_b32 v73, v6 offset:128
    ds_read_b32 v74, v6 offset:256
    ds_read_b32 v75, v6 offset:384
    ds_read_b32 v76, v6 offset:512
    ds_read_b32 v77, v6 offset:640
    ds_read_b32 v78, v6 offset:768
    ds_read_b32 v79, v6 offset:896
    v_lshlrev_b32 v9, 16, v9
    v_lshlrev_b32 v10, 16, v10
    v_add_f32 v9, v9, v10
    s_waitcnt lgkmcnt(0)
    v_add_f32 v72, v72, v73
    v_add_f32 v74, v74, v75
    v_add_f32 v76, v76, v77
    v_add_f32 v78, v78, v79
    v_add_f32 v72, v72, v74
    v_add_f32 v76, v76, v78
    v_add_f32 v72, v72, v76
    v_add_f32 v72, v72, v9
    v_cvt_pk_bf16_f32 v72, v72, v72
    v_cmp_gt_u32 vcc, 32, v0
    s_and_saveexec_b64 s[54:55], vcc
    buffer_store_short v72, v8, s[68:71], s59 offen
    s_mov_b64 exec, s[54:55]
    s_cmp_eq_u32 s2, 0
    s_cbranch_scc0 L_fin
    v_mov_b32 v74, s82
    v_mov_b32 v75, s83
    v_mov_b32 v6, 262144
    v_cmp_eq_u32 vcc, 0, v0
    s_and_saveexec_b64 s[54:55], vcc
    buffer_store_dwordx2 v[74:75], v6, s[36:39], 0 offen
    s_mov_b64 exec, s[54:55]
    s_branch L_fin
L_aux:
    s_sub_u32 s30, s30, 8
    s_setprio 3
    s_mov_b32 s40, s4
    s_mov_b32 s41, s5
    s_mov_b32 s42, 2048
    s_mov_b32 s43, 0x20000
    s_mov_b32 s44, s10
    s_mov_b32 s45, s11
    s_mov_b32 s46, 0x400000
    s_mov_b32 s47, 0x20000
    s_mov_b32 s48, s16
    s_mov_b32 s49, s17
    s_mov_b32 s50, 1835008
    s_mov_b32 s51, 0x20000
    s_mov_b32 s52, s12
    s_mov_b32 s53, s13
    s_mov_b32 s54, 0x400000
    s_mov_b32 s55, 0x20000
    s_mov_b32 s56, s20
    s_mov_b32 s57, s21
    s_mov_b32 s58, 1835008
    s_mov_b32 s59, 0x20000
    s_mov_b32 s60, s18
    s_mov_b32 s61, s19
    s_mov_b32 s62, 3584
    s_mov_b32 s63, 0x20000
    s_mul_i32 s68, s35, 28
    s_add_u32 s68, s68, s32
    s_cmp_eq_u32 s30, 0
    s_cbranch_scc1 L_a0
    s_cmp_eq_u32 s30, 1
    s_cbranch_scc1 L_a1
    s_cmp_eq_u32 s30, 2
    s_cbranch_scc1 L_a2
    v_mov_b32 v5, 161536
    v_lshl_add_u32 v5, v0, 2, v5
    v_mov_b32 v6, 0
    v_cmp_gt_u32 vcc, 8, v0
    s_and_saveexec_b64 s[70:71], vcc
    ds_write_b32 v5, v6
    s_mov_b64 exec, s[70:71]
    s_waitcnt lgkmcnt(0)
    s_barrier
    s_load_dwordx2 s[80:81], s[28:29], 262144
    s_waitcnt lgkmcnt(0)
    s_add_u32 s82, s80, 1
    s_addc_u32 s83, s81, 0
    s_and_b32 s84, s82, 0xfff
    s_bfe_u32 s85, s82, 0xc000c
    s_lshr_b32 s86, s82, 24
    s_lshl_b32 s87, s83, 8
    s_or_b32 s86, s86, s87
    s_and_b32 s86, s86, 0xfff
    s_bfe_u32 s87, s83, 0xc0004
    s_and_b32 s64, s82, 0xff
    s_bfe_u32 s65, s82, 0x80008
    s_bfe_u32 s66, s82, 0x80010
    s_lshr_b32 s67, s82, 24
    s_getreg_b32 s72, hwreg(HW_REG_XCC_ID)
    v_mov_b32 v8, s72
    v_mov_b32 v9, 0
    v_mov_b32 v10, s82
    v_mov_b32 v11, s83
    s_lshl_b32 s72, s2, 4
    s_add_u32 s72, s72, 131072
    v_mov_b32 v5, 0
    v_cmp_eq_u32 vcc, 0, v0
    s_and_saveexec_b64 s[70:71], vcc
    buffer_store_dwordx4 v[8:11], v5, s[36:39], s72 offen sc1
    s_mov_b64 exec, s[70:71]
    s_branch L_acommon
L_a0:
    buffer_load_dwordx4 v[8:11], v4, s[40:43], 0 offen
    buffer_load_dwordx4 v[12:15], v4, s[40:43], 0 offen offset:1024
    v_lshrrev_b32 v5, 3, v0
    v_lshlrev_b32 v5, 13, v5
    v_and_b32 v6, 7, v0
    v_lshl_add_u32 v5, v6, 4, v5
    s_lshl_b32 s72, s35, 10
    s_and_b32 s73, s32, 7
    s_lshl_b32 s73, s73, 7
    s_add_u32 s72, s72, s73
    s_lshr_b32 s73, s32, 3
    s_lshl_b32 s73, s73, 20
    s_add_u32 s72, s72, s73
    s_mov_b32 m0, 131072
    buffer_load_dwordx4 v5, s[44:47], s72 offen nt lds
    s_add_u32 s72, s72, 65536
    s_mov_b32 m0, 132096
    buffer_load_dwordx4 v5, s[44:47], s72 offen nt lds
    s_add_u32 s72, s72, 65536
    s_mov_b32 m0, 133120
    buffer_load_dwordx4 v5, s[44:47], s72 offen nt lds
    s_add_u32 s72, s72, 65536
    s_mov_b32 m0, 134144
    buffer_load_dwordx4 v5, s[44:47], s72 offen nt lds
    s_add_u32 s72, s72, 65536
    s_mov_b32 m0, 135168
    buffer_load_dwordx4 v5, s[44:47], s72 offen nt lds
    s_add_u32 s72, s72, 65536
    s_mov_b32 m0, 136192
    buffer_load_dwordx4 v5, s[44:47], s72 offen nt lds
    s_add_u32 s72, s72, 65536
    s_mov_b32 m0, 137216
    buffer_load_dwordx4 v5, s[44:47], s72 offen nt lds
    s_add_u32 s72, s72, 65536
    s_mov_b32 m0, 138240
    buffer_load_dwordx4 v5, s[44:47], s72 offen nt lds
    s_add_u32 s72, s72, 65536
    s_mov_b32 m0, 139264
    buffer_load_dwordx4 v5, s[44:47], s72 offen nt lds
    s_add_u32 s72, s72, 65536
    s_mov_b32 m0, 140288
    buffer_load_dwordx4 v5, s[44:47], s72 offen nt lds
    s_add_u32 s72, s72, 65536
    s_mov_b32 m0, 141312
    buffer_load_dwordx4 v5, s[44:47], s72 offen nt lds
    s_add_u32 s72, s72, 65536
    s_mov_b32 m0, 142336
    buffer_load_dwordx4 v5, s[44:47], s72 offen nt lds
    s_add_u32 s72, s72, 65536
    s_mov_b32 m0, 143360
    buffer_load_dwordx4 v5, s[44:47], s72 offen nt lds
    s_add_u32 s72, s72, 65536
    s_mov_b32 m0, 144384
    buffer_load_dwordx4 v5, s[44:47], s72 offen nt lds
    s_add_u32 s72, s72, 65536
    s_mov_b32 m0, 145408
    buffer_load_dwordx4 v5, s[44:47], s72 offen nt lds
    s_add_u32 s72, s72, 65536
    s_mov_b32 m0, 146432
    buffer_load_dwordx4 v5, s[44:47], s72 offen nt lds
    s_barrier
    s_load_dwordx2 s[80:81], s[28:29], 262144
    s_waitcnt vmcnt(16)
    s_waitcnt lgkmcnt(0)
    s_add_u32 s82, s80, 1
    s_addc_u32 s83, s81, 0
    s_and_b32 s84, s82, 0xfff
    s_bfe_u32 s85, s82, 0xc000c
    s_lshr_b32 s86, s82, 24
    s_lshl_b32 s87, s83, 8
    s_or_b32 s86, s86, s87
    s_and_b32 s86, s86, 0xfff
    s_bfe_u32 s87, s83, 0xc0004
    s_and_b32 s64, s82, 0xff
    s_bfe_u32 s65, s82, 0x80008
    s_bfe_u32 s66, s82, 0x80010
    s_lshr_b32 s67, s82, 24
    v_lshlrev_b32 v16, 16, v8
    v_and_b32 v17, 0xffff0000, v8
    v_lshlrev_b32 v18, 16, v9
    v_and_b32 v19, 0xffff0000, v9
    v_lshlrev_b32 v20, 16, v10
    v_and_b32 v21, 0xffff0000, v10
    v_lshlrev_b32 v22, 16, v11
    v_and_b32 v23, 0xffff0000, v11
    v_add_f32 v24, v16, v17
    v_add_f32 v24, v24, v18
    v_add_f32 v24, v24, v19
    v_add_f32 v24, v24, v20
    v_add_f32 v24, v24, v21
    v_add_f32 v24, v24, v22
    v_add_f32 v24, v24, v23
    s_nop 1
    v_add_f32_dpp v24, v24, v24 row_ror:8 row_mask:0xf bank_mask:0xf
    s_nop 1
    v_add_f32_dpp v24, v24, v24 row_ror:4 row_mask:0xf bank_mask:0xf
    s_nop 1
    v_add_f32_dpp v24, v24, v24 row_ror:2 row_mask:0xf bank_mask:0xf
    s_nop 1
    v_add_f32_dpp v24, v24, v24 row_ror:1 row_mask:0xf bank_mask:0xf
    s_nop 0
    v_mov_b32 v26, v24
    v_mov_b32 v27, v24
    s_nop 1
    v_permlane16_swap_b32 v26, v27
    s_nop 0
    v_add_f32 v24, v26, v27
    v_mov_b32 v26, v24
    v_mov_b32 v27, v24
    s_nop 1
    v_permlane32_swap_b32 v26, v27
    s_nop 0
    v_add_f32 v24, v26, v27
    v_mul_f32 v24, 0x3b000000, v24
    v_mov_b32 v25, 0
    v_sub_f32 v26, v16, v24
    v_fmac_f32 v25, v26, v26
    v_sub_f32 v26, v17, v24
    v_fmac_f32 v25, v26, v26
    v_sub_f32 v26, v18, v24
    v_fmac_f32 v25, v26, v26
    v_sub_f32 v26, v19, v24
    v_fmac_f32 v25, v26, v26
    v_sub_f32 v26, v20, v24
    v_fmac_f32 v25, v26, v26
    v_sub_f32 v26, v21, v24
    v_fmac_f32 v25, v26, v26
    v_sub_f32 v26, v22, v24
    v_fmac_f32 v25, v26, v26
    v_sub_f32 v26, v23, v24
    v_fmac_f32 v25, v26, v26
    s_nop 1
    v_add_f32_dpp v25, v25, v25 row_ror:8 row_mask:0xf bank_mask:0xf
    s_nop 1
    v_add_f32_dpp v25, v25, v25 row_ror:4 row_mask:0xf bank_mask:0xf
    s_nop 1
    v_add_f32_dpp v25, v25, v25 row_ror:2 row_mask:0xf bank_mask:0xf
    s_nop 1
    v_add_f32_dpp v25, v25, v25 row_ror:1 row_mask:0xf bank_mask:0xf
    s_nop 0
    v_mov_b32 v26, v25
    v_mov_b32 v27, v25
    s_nop 1
    v_permlane16_swap_b32 v26, v27
    s_nop 0
    v_add_f32 v25, v26, v27
    v_mov_b32 v26, v25
    v_mov_b32 v27, v25
    s_nop 1
    v_permlane32_swap_b32 v26, v27
    s_nop 0
    v_add_f32 v25, v26, v27
    v_mul_f32 v25, 0x3b000000, v25
    v_cvt_pk_bf16_f32 v26, v24, v25
    v_lshlrev_b32 v24, 16, v26
    v_and_b32 v25, 0xffff0000, v26
    v_add_f32 v25, 0x3727c5ac, v25
    v_cvt_pk_bf16_f32 v25, v25, v25
    v_and_b32 v25, 0xffff0000, v25
    v_sqrt_f32 v25, v25
    s_nop 0
    v_cvt_pk_bf16_f32 v25, v25, v25
    v_and_b32 v25, 0xffff0000, v25
    v_rcp_f32 v28, v25
    v_sub_f32 v16, v16, v24
    v_sub_f32 v17, v17, v24
    v_sub_f32 v18, v18, v24
    v_sub_f32 v19, v19, v24
    v_sub_f32 v20, v20, v24
    v_sub_f32 v21, v21, v24
    v_sub_f32 v22, v22, v24
    v_sub_f32 v23, v23, v24
    v_cvt_pk_bf16_f32 v26, v16, v17
    v_lshlrev_b32 v16, 16, v26
    v_and_b32 v17, 0xffff0000, v26
    v_cvt_pk_bf16_f32 v26, v18, v19
    v_lshlrev_b32 v18, 16, v26
    v_and_b32 v19, 0xffff0000, v26
    v_cvt_pk_bf16_f32 v26, v20, v21
    v_lshlrev_b32 v20, 16, v26
    v_and_b32 v21, 0xffff0000, v26
    v_cvt_pk_bf16_f32 v26, v22, v23
    v_lshlrev_b32 v22, 16, v26
    v_and_b32 v23, 0xffff0000, v26
    v_mul_f32 v26, v16, v28
    v_fma_f32 v27, -v26, v25, v16
    v_fma_f32 v16, v27, v28, v26
    v_mul_f32 v26, v17, v28
    v_fma_f32 v27, -v26, v25, v17
    v_fma_f32 v17, v27, v28, v26
    v_mul_f32 v26, v18, v28
    v_fma_f32 v27, -v26, v25, v18
    v_fma_f32 v18, v27, v28, v26
    v_mul_f32 v26, v19, v28
    v_fma_f32 v27, -v26, v25, v19
    v_fma_f32 v19, v27, v28, v26
    v_mul_f32 v26, v20, v28
    v_fma_f32 v27, -v26, v25, v20
    v_fma_f32 v20, v27, v28, v26
    v_mul_f32 v26, v21, v28
    v_fma_f32 v27, -v26, v25, v21
    v_fma_f32 v21, v27, v28, v26
    v_mul_f32 v26, v22, v28
    v_fma_f32 v27, -v26, v25, v22
    v_fma_f32 v22, v27, v28, v26
    v_mul_f32 v26, v23, v28
    v_fma_f32 v27, -v26, v25, v23
    v_fma_f32 v23, v27, v28, v26
    v_cvt_pk_bf16_f32 v8, v16, v17
    v_cvt_pk_bf16_f32 v9, v18, v19
    v_cvt_pk_bf16_f32 v10, v20, v21
    v_cvt_pk_bf16_f32 v11, v22, v23
    v_lshlrev_b32 v16, 16, v12
    v_and_b32 v17, 0xffff0000, v12
    v_lshlrev_b32 v18, 16, v13
    v_and_b32 v19, 0xffff0000, v13
    v_lshlrev_b32 v20, 16, v14
    v_and_b32 v21, 0xffff0000, v14
    v_lshlrev_b32 v22, 16, v15
    v_and_b32 v23, 0xffff0000, v15
    v_add_f32 v24, v16, v17
    v_add_f32 v24, v24, v18
    v_add_f32 v24, v24, v19
    v_add_f32 v24, v24, v20
    v_add_f32 v24, v24, v21
    v_add_f32 v24, v24, v22
    v_add_f32 v24, v24, v23
    s_nop 1
    v_add_f32_dpp v24, v24, v24 row_ror:8 row_mask:0xf bank_mask:0xf
    s_nop 1
    v_add_f32_dpp v24, v24, v24 row_ror:4 row_mask:0xf bank_mask:0xf
    s_nop 1
    v_add_f32_dpp v24, v24, v24 row_ror:2 row_mask:0xf bank_mask:0xf
    s_nop 1
    v_add_f32_dpp v24, v24, v24 row_ror:1 row_mask:0xf bank_mask:0xf
    s_nop 0
    v_mov_b32 v26, v24
    v_mov_b32 v27, v24
    s_nop 1
    v_permlane16_swap_b32 v26, v27
    s_nop 0
    v_add_f32 v24, v26, v27
    v_mov_b32 v26, v24
    v_mov_b32 v27, v24
    s_nop 1
    v_permlane32_swap_b32 v26, v27
    s_nop 0
    v_add_f32 v24, v26, v27
    v_mul_f32 v24, 0x3b000000, v24
    v_mov_b32 v25, 0
    v_sub_f32 v26, v16, v24
    v_fmac_f32 v25, v26, v26
    v_sub_f32 v26, v17, v24
    v_fmac_f32 v25, v26, v26
    v_sub_f32 v26, v18, v24
    v_fmac_f32 v25, v26, v26
    v_sub_f32 v26, v19, v24
    v_fmac_f32 v25, v26, v26
    v_sub_f32 v26, v20, v24
    v_fmac_f32 v25, v26, v26
    v_sub_f32 v26, v21, v24
    v_fmac_f32 v25, v26, v26
    v_sub_f32 v26, v22, v24
    v_fmac_f32 v25, v26, v26
    v_sub_f32 v26, v23, v24
    v_fmac_f32 v25, v26, v26
    s_nop 1
    v_add_f32_dpp v25, v25, v25 row_ror:8 row_mask:0xf bank_mask:0xf
    s_nop 1
    v_add_f32_dpp v25, v25, v25 row_ror:4 row_mask:0xf bank_mask:0xf
    s_nop 1
    v_add_f32_dpp v25, v25, v25 row_ror:2 row_mask:0xf bank_mask:0xf
    s_nop 1
    v_add_f32_dpp v25, v25, v25 row_ror:1 row_mask:0xf bank_mask:0xf
    s_nop 0
    v_mov_b32 v26, v25
    v_mov_b32 v27, v25
    s_nop 1
    v_permlane16_swap_b32 v26, v27
    s_nop 0
    v_add_f32 v25, v26, v27
    v_mov_b32 v26, v25
    v_mov_b32 v27, v25
    s_nop 1
    v_permlane32_swap_b32 v26, v27
    s_nop 0
    v_add_f32 v25, v26, v27
    v_mul_f32 v25, 0x3b000000, v25
    v_cvt_pk_bf16_f32 v26, v24, v25
    v_lshlrev_b32 v24, 16, v26
    v_and_b32 v25, 0xffff0000, v26
    v_add_f32 v25, 0x3727c5ac, v25
    v_cvt_pk_bf16_f32 v25, v25, v25
    v_and_b32 v25, 0xffff0000, v25
    v_sqrt_f32 v25, v25
    s_nop 0
    v_cvt_pk_bf16_f32 v25, v25, v25
    v_and_b32 v25, 0xffff0000, v25
    v_rcp_f32 v28, v25
    v_sub_f32 v16, v16, v24
    v_sub_f32 v17, v17, v24
    v_sub_f32 v18, v18, v24
    v_sub_f32 v19, v19, v24
    v_sub_f32 v20, v20, v24
    v_sub_f32 v21, v21, v24
    v_sub_f32 v22, v22, v24
    v_sub_f32 v23, v23, v24
    v_cvt_pk_bf16_f32 v26, v16, v17
    v_lshlrev_b32 v16, 16, v26
    v_and_b32 v17, 0xffff0000, v26
    v_cvt_pk_bf16_f32 v26, v18, v19
    v_lshlrev_b32 v18, 16, v26
    v_and_b32 v19, 0xffff0000, v26
    v_cvt_pk_bf16_f32 v26, v20, v21
    v_lshlrev_b32 v20, 16, v26
    v_and_b32 v21, 0xffff0000, v26
    v_cvt_pk_bf16_f32 v26, v22, v23
    v_lshlrev_b32 v22, 16, v26
    v_and_b32 v23, 0xffff0000, v26
    v_mul_f32 v26, v16, v28
    v_fma_f32 v27, -v26, v25, v16
    v_fma_f32 v16, v27, v28, v26
    v_mul_f32 v26, v17, v28
    v_fma_f32 v27, -v26, v25, v17
    v_fma_f32 v17, v27, v28, v26
    v_mul_f32 v26, v18, v28
    v_fma_f32 v27, -v26, v25, v18
    v_fma_f32 v18, v27, v28, v26
    v_mul_f32 v26, v19, v28
    v_fma_f32 v27, -v26, v25, v19
    v_fma_f32 v19, v27, v28, v26
    v_mul_f32 v26, v20, v28
    v_fma_f32 v27, -v26, v25, v20
    v_fma_f32 v20, v27, v28, v26
    v_mul_f32 v26, v21, v28
    v_fma_f32 v27, -v26, v25, v21
    v_fma_f32 v21, v27, v28, v26
    v_mul_f32 v26, v22, v28
    v_fma_f32 v27, -v26, v25, v22
    v_fma_f32 v22, v27, v28, v26
    v_mul_f32 v26, v23, v28
    v_fma_f32 v27, -v26, v25, v23
    v_fma_f32 v23, v27, v28, v26
    v_cvt_pk_bf16_f32 v12, v16, v17
    v_cvt_pk_bf16_f32 v13, v18, v19
    v_cvt_pk_bf16_f32 v14, v20, v21
    v_cvt_pk_bf16_f32 v15, v22, v23
    v_add_u32 v5, 155648, v4
    ds_write_b128 v5, v[8:11]
    ds_write_b128 v5, v[12:15] offset:1024
    s_waitcnt vmcnt(0) lgkmcnt(0)
    s_lshr_b32 s73, s32, 3
    s_lshl_b32 s73, s73, 8
    s_add_u32 s73, s73, 155648
    v_lshrrev_b32 v5, 2, v3
    v_lshl_add_u32 v5, v2, 3, v5
    v_lshlrev_b32 v5, 7, v5
    v_and_b32 v6, 3, v3
    v_lshl_add_u32 v5, v6, 3, v5
    v_add_u32 v5, 131072, v5
    v_lshrrev_b32 v30, 3, v3
    v_lshlrev_b32 v30, 10, v30
    v_lshl_add_u32 v30, v2, 4, v30
    v_add_u32 v30, s73, v30
    ds_read_b128 v[48:51], v30 offset:0
    ds_read_b64_tr_b16 v[32:33], v5 offset:0
    ds_read_b64_tr_b16 v[34:35], v5 offset:512
    ds_read_b64_tr_b16 v[36:37], v5 offset:32
    ds_read_b64_tr_b16 v[38:39], v5 offset:544
    ds_read_b64_tr_b16 v[40:41], v5 offset:64
    ds_read_b64_tr_b16 v[42:43], v5 offset:576
    ds_read_b64_tr_b16 v[44:45], v5 offset:96
    ds_read_b64_tr_b16 v[46:47], v5 offset:608
    s_waitcnt lgkmcnt(6)
    v_mfma_f32_16x16x32_bf16 v[64:67], v[32:35], v[48:51], 0
    s_waitcnt lgkmcnt(4)
    v_mfma_f32_16x16x32_bf16 v[68:71], v[36:39], v[48:51], 0
    s_waitcnt lgkmcnt(2)
    v_mfma_f32_16x16x32_bf16 v[72:75], v[40:43], v[48:51], 0
    s_waitcnt lgkmcnt(0)
    v_mfma_f32_16x16x32_bf16 v[76:79], v[44:47], v[48:51], 0
    ds_read_b128 v[48:51], v30 offset:64
    ds_read_b64_tr_b16 v[32:33], v5 offset:4096
    ds_read_b64_tr_b16 v[34:35], v5 offset:4608
    ds_read_b64_tr_b16 v[36:37], v5 offset:4128
    ds_read_b64_tr_b16 v[38:39], v5 offset:4640
    ds_read_b64_tr_b16 v[40:41], v5 offset:4160
    ds_read_b64_tr_b16 v[42:43], v5 offset:4672
    ds_read_b64_tr_b16 v[44:45], v5 offset:4192
    ds_read_b64_tr_b16 v[46:47], v5 offset:4704
    s_waitcnt lgkmcnt(6)
    v_mfma_f32_16x16x32_bf16 v[64:67], v[32:35], v[48:51], v[64:67]
    s_waitcnt lgkmcnt(4)
    v_mfma_f32_16x16x32_bf16 v[68:71], v[36:39], v[48:51], v[68:71]
    s_waitcnt lgkmcnt(2)
    v_mfma_f32_16x16x32_bf16 v[72:75], v[40:43], v[48:51], v[72:75]
    s_waitcnt lgkmcnt(0)
    v_mfma_f32_16x16x32_bf16 v[76:79], v[44:47], v[48:51], v[76:79]
    ds_read_b128 v[48:51], v30 offset:128
    ds_read_b64_tr_b16 v[32:33], v5 offset:8192
    ds_read_b64_tr_b16 v[34:35], v5 offset:8704
    ds_read_b64_tr_b16 v[36:37], v5 offset:8224
    ds_read_b64_tr_b16 v[38:39], v5 offset:8736
    ds_read_b64_tr_b16 v[40:41], v5 offset:8256
    ds_read_b64_tr_b16 v[42:43], v5 offset:8768
    ds_read_b64_tr_b16 v[44:45], v5 offset:8288
    ds_read_b64_tr_b16 v[46:47], v5 offset:8800
    s_waitcnt lgkmcnt(6)
    v_mfma_f32_16x16x32_bf16 v[64:67], v[32:35], v[48:51], v[64:67]
    s_waitcnt lgkmcnt(4)
    v_mfma_f32_16x16x32_bf16 v[68:71], v[36:39], v[48:51], v[68:71]
    s_waitcnt lgkmcnt(2)
    v_mfma_f32_16x16x32_bf16 v[72:75], v[40:43], v[48:51], v[72:75]
    s_waitcnt lgkmcnt(0)
    v_mfma_f32_16x16x32_bf16 v[76:79], v[44:47], v[48:51], v[76:79]
    ds_read_b128 v[48:51], v30 offset:192
    ds_read_b64_tr_b16 v[32:33], v5 offset:12288
    ds_read_b64_tr_b16 v[34:35], v5 offset:12800
    ds_read_b64_tr_b16 v[36:37], v5 offset:12320
    ds_read_b64_tr_b16 v[38:39], v5 offset:12832
    ds_read_b64_tr_b16 v[40:41], v5 offset:12352
    ds_read_b64_tr_b16 v[42:43], v5 offset:12864
    ds_read_b64_tr_b16 v[44:45], v5 offset:12384
    ds_read_b64_tr_b16 v[46:47], v5 offset:12896
    s_waitcnt lgkmcnt(6)
    v_mfma_f32_16x16x32_bf16 v[64:67], v[32:35], v[48:51], v[64:67]
    s_waitcnt lgkmcnt(4)
    v_mfma_f32_16x16x32_bf16 v[68:71], v[36:39], v[48:51], v[68:71]
    s_waitcnt lgkmcnt(2)
    v_mfma_f32_16x16x32_bf16 v[72:75], v[40:43], v[48:51], v[72:75]
    s_waitcnt lgkmcnt(0)
    v_mfma_f32_16x16x32_bf16 v[76:79], v[44:47], v[48:51], v[76:79]
    s_nop 7
    s_nop 1
    v_and_b32 v6, 3, v3
    v_mov_b32 v16, v64
    v_mov_b32 v17, v65
    v_mov_b32 v18, v66
    v_mov_b32 v19, v67
    v_cmp_eq_u32 vcc, 1, v6
    s_nop 1
    v_cndmask_b32 v16, v16, v68, vcc
    v_cndmask_b32 v17, v17, v69, vcc
    v_cndmask_b32 v18, v18, v70, vcc
    v_cndmask_b32 v19, v19, v71, vcc
    v_cmp_eq_u32 vcc, 2, v6
    s_nop 1
    v_cndmask_b32 v16, v16, v72, vcc
    v_cndmask_b32 v17, v17, v73, vcc
    v_cndmask_b32 v18, v18, v74, vcc
    v_cndmask_b32 v19, v19, v75, vcc
    v_cmp_eq_u32 vcc, 3, v6
    s_nop 1
    v_cndmask_b32 v16, v16, v76, vcc
    v_cndmask_b32 v17, v17, v77, vcc
    v_cndmask_b32 v18, v18, v78, vcc
    v_cndmask_b32 v19, v19, v79, vcc
    v_mov_b32 v20, 0xffffff00
    v_add_u32 v16, 0x80, v16
    v_add_u32 v17, 0x80, v17
    v_add_u32 v18, 0x80, v18
    v_add_u32 v19, 0x80, v19
    v_and_or_b32 v16, v16, v20, s64
    v_and_or_b32 v17, v17, v20, s65
    v_and_or_b32 v18, v18, v20, s66
    v_and_or_b32 v19, v19, v20, s67
    v_lshlrev_b32 v7, 6, v6
    v_lshl_add_u32 v7, v2, 4, v7
    v_and_b32 v6, 4, v3
    v_cmp_eq_u32 vcc, 0, v6
    v_lshrrev_b32 v6, 3, v3
    v_lshl_add_u32 v7, v6, 13, v7
    s_lshl_b32 s69, s35, 14
    s_lshr_b32 s72, s32, 3
    s_lshl_b32 s72, s72, 11
    s_add_u32 s69, s69, s72
    s_and_b32 s72, s32, 7
    s_lshl_b32 s72, s72, 8
    s_add_u32 s69, s69, s72
    s_add_u32 s69, s69, 524288
    s_and_saveexec_b64 s[70:71], vcc
    buffer_store_dwordx4 v[16:19], v7, s[36:39], s69 offen sc1
    s_mov_b64 exec, s[70:71]
    v_mov_b32 v5, 161548
    v_mov_b32 v6, 1
    ds_write_b32 v5, v6
    s_branch L_acommon
L_a1:
    s_barrier
    s_load_dwordx2 s[80:81], s[28:29], 262144
    s_waitcnt lgkmcnt(0)
    s_add_u32 s82, s80, 1
    s_addc_u32 s83, s81, 0
    s_and_b32 s84, s82, 0xfff
    s_bfe_u32 s85, s82, 0xc000c
    s_lshr_b32 s86, s82, 24
    s_lshl_b32 s87, s83, 8
    s_or_b32 s86, s86, s87
    s_and_b32 s86, s86, 0xfff
    s_bfe_u32 s87, s83, 0xc0004
    s_and_b32 s64, s82, 0xff
    s_bfe_u32 s65, s82, 0x80008
    s_bfe_u32 s66, s82, 0x80010
    s_lshr_b32 s67, s82, 24
    v_mov_b32 v5, 161548
L_a1_p:
    ds_read_b32 v6, v5
    s_waitcnt lgkmcnt(0)
    v_readfirstlane_b32 s75, v6
    s_cmp_eq_u32 s75, 0
    s_cbranch_scc0 L_a1_p_d
    s_sleep 4
    s_branch L_a1_p
L_a1_p_d:
    s_lshl_b32 s72, s89, 14
    s_lshl_b32 s73, s88, 13
    s_add_u32 s72, s72, s73
    s_add_u32 s72, s72, 524288
    s_add_u32 s73, s72, 4096
    s_sleep 60
L_a1_q:
    buffer_load_dwordx4 v[8:11], v4, s[36:39], s72 offen offset:0 sc1
    buffer_load_dwordx4 v[12:15], v4, s[36:39], s72 offen offset:1024 sc1
    buffer_load_dwordx4 v[16:19], v4, s[36:39], s72 offen offset:2048 sc1
    buffer_load_dwordx4 v[20:23], v4, s[36:39], s72 offen offset:3072 sc1
    buffer_load_dwordx4 v[24:27], v4, s[36:39], s73 offen offset:0 sc1
    buffer_load_dwordx4 v[28:31], v4, s[36:39], s73 offen offset:1024 sc1
    buffer_load_dwordx4 v[32:35], v4, s[36:39], s73 offen offset:2048 sc1
    buffer_load_dwordx4 v[36:39], v4, s[36:39], s73 offen offset:3072 sc1
    s_waitcnt vmcnt(0)
    v_xor_b32 v8, s64, v8
    v_xor_b32 v9, s65, v9
    v_xor_b32 v10, s66, v10
    v_xor_b32 v11, s67, v11
    v_xor_b32 v12, s64, v12
    v_xor_b32 v13, s65, v13
    v_xor_b32 v14, s66, v14
    v_xor_b32 v15, s67, v15
    v_xor_b32 v16, s64, v16
    v_xor_b32 v17, s65, v17
    v_xor_b32 v18, s66, v18
    v_xor_b32 v19, s67, v19
    v_xor_b32 v20, s64, v20
    v_xor_b32 v21, s65, v21
    v_xor_b32 v22, s66, v22
    v_xor_b32 v23, s67, v23
    v_xor_b32 v24, s64, v24
    v_xor_b32 v25, s65, v25
    v_xor_b32 v26, s66, v26
    v_xor_b32 v27, s67, v27
    v_xor_b32 v28, s64, v28
    v_xor_b32 v29, s65, v29
    v_xor_b32 v30, s66, v30
    v_xor_b32 v31, s67, v31
    v_xor_b32 v32, s64, v32
    v_xor_b32 v33, s65, v33
    v_xor_b32 v34, s66, v34
    v_xor_b32 v35, s67, v35
    v_xor_b32 v36, s64, v36
    v_xor_b32 v37, s65, v37
    v_xor_b32 v38, s66, v38
    v_xor_b32 v39, s67, v39
    v_or3_b32 v6, v8, v9, v10
    v_or3_b32 v6, v6, v11, v12
    v_or3_b32 v6, v6, v13, v14
    v_or3_b32 v6, v6, v15, v16
    v_or3_b32 v6, v6, v17, v18
    v_or3_b32 v6, v6, v19, v20
    v_or3_b32 v6, v6, v21, v22
    v_or3_b32 v6, v6, v23, v24
    v_or3_b32 v6, v6, v25, v26
    v_or3_b32 v6, v6, v27, v28
    v_or3_b32 v6, v6, v29, v30
    v_or3_b32 v6, v6, v31, v32
    v_or3_b32 v6, v6, v33, v34
    v_or3_b32 v6, v6, v35, v36
    v_or3_b32 v6, v6, v37, v38
    v_or_b32 v6, v6, v39
    v_and_b32 v6, 0xff, v6
    v_cmp_ne_u32 vcc, 0, v6
    s_cbranch_vccz L_a1_qd
    s_sleep 16
    s_branch L_a1_q
L_a1_qd:
    v_pk_add_f32 v[8:9], v[8:9], v[16:17]
    v_pk_add_f32 v[24:25], v[24:25], v[32:33]
    v_pk_add_f32 v[10:11], v[10:11], v[18:19]
    v_pk_add_f32 v[26:27], v[26:27], v[34:35]
    v_pk_add_f32 v[12:13], v[12:13], v[20:21]
    v_pk_add_f32 v[28:29], v[28:29], v[36:37]
    v_pk_add_f32 v[14:15], v[14:15], v[22:23]
    v_pk_add_f32 v[30:31], v[30:31], v[38:39]
    v_pk_add_f32 v[8:9], v[8:9], v[24:25]
    v_pk_add_f32 v[10:11], v[10:11], v[26:27]
    v_pk_add_f32 v[12:13], v[12:13], v[28:29]
    v_pk_add_f32 v[14:15], v[14:15], v[30:31]
    v_cvt_pk_bf16_f32 v16, v8, v9
    v_cvt_pk_bf16_f32 v17, v10, v11
    v_cvt_pk_bf16_f32 v18, v12, v13
    v_cvt_pk_bf16_f32 v19, v14, v15
    v_lshlrev_b32 v5, 3, v0
    v_add_u32 v5, 159744, v5
    ds_write_b64 v5, v[16:17]
    ds_write_b64 v5, v[18:19] offset:512
    s_waitcnt lgkmcnt(0)
    v_mov_b32 v5, 161536
    v_mov_b32 v6, 1
    ds_write_b32 v5, v6
    s_branch L_acommon
L_a2:
    s_cmp_ge_u32 s32, 28
    s_cbranch_scc1 L_a2_skip
    buffer_load_dwordx4 v[8:11], v4, s[40:43], 0 offen
    buffer_load_dwordx4 v[12:15], v4, s[40:43], 0 offen offset:1024
    s_mov_b32 s72, 3584
    v_lshrrev_b32 v5, 3, v0
    v_mul_lo_u32 v5, v5, s72
    v_and_b32 v6, 7, v0
    v_lshl_add_u32 v5, v6, 4, v5
    s_mul_i32 s72, s35, 229376
    s_lshl_b32 s73, s32, 7
    s_add_u32 s72, s72, s73
    s_mov_b32 m0, 147456
    buffer_load_dwordx4 v5, s[48:51], s72 offen nt lds
    s_add_u32 s72, s72, 28672
    s_mov_b32 m0, 148480
    buffer_load_dwordx4 v5, s[48:51], s72 offen nt lds
    s_add_u32 s72, s72, 28672
    s_mov_b32 m0, 149504
    buffer_load_dwordx4 v5, s[48:51], s72 offen nt lds
    s_add_u32 s72, s72, 28672
    s_mov_b32 m0, 150528
    buffer_load_dwordx4 v5, s[48:51], s72 offen nt lds
    s_add_u32 s72, s72, 28672
    s_mov_b32 m0, 151552
    buffer_load_dwordx4 v5, s[48:51], s72 offen nt lds
    s_add_u32 s72, s72, 28672
    s_mov_b32 m0, 152576
    buffer_load_dwordx4 v5, s[48:51], s72 offen nt lds
    s_add_u32 s72, s72, 28672
    s_mov_b32 m0, 153600
    buffer_load_dwordx4 v5, s[48:51], s72 offen nt lds
    s_add_u32 s72, s72, 28672
    s_mov_b32 m0, 154624
    buffer_load_dwordx4 v5, s[48:51], s72 offen nt lds
    v_and_b32 v6, 1, v2
    v_lshlrev_b32 v6, 3, v6
    s_lshl_b32 s72, s68, 4
    buffer_load_dwordx2 v[80:81], v6, s[60:63], s72 offen
    s_barrier
    s_load_dwordx2 s[80:81], s[28:29], 262144
    s_waitcnt vmcnt(9)
    s_waitcnt lgkmcnt(0)
    s_add_u32 s82, s80, 1
    s_addc_u32 s83, s81, 0
    s_and_b32 s84, s82, 0xfff
    s_bfe_u32 s85, s82, 0xc000c
    s_lshr_b32 s86, s82, 24
    s_lshl_b32 s87, s83, 8
    s_or_b32 s86, s86, s87
    s_and_b32 s86, s86, 0xfff
    s_bfe_u32 s87, s83, 0xc0004
    s_and_b32 s64, s82, 0xff
    s_bfe_u32 s65, s82, 0x80008
    s_bfe_u32 s66, s82, 0x80010
    s_lshr_b32 s67, s82, 24
    v_lshlrev_b32 v16, 16, v8
    v_and_b32 v17, 0xffff0000, v8
    v_lshlrev_b32 v18, 16, v9
    v_and_b32 v19, 0xffff0000, v9
    v_lshlrev_b32 v20, 16, v10
    v_and_b32 v21, 0xffff0000, v10
    v_lshlrev_b32 v22, 16, v11
    v_and_b32 v23, 0xffff0000, v11
    v_add_f32 v24, v16, v17
    v_add_f32 v24, v24, v18
    v_add_f32 v24, v24, v19
    v_add_f32 v24, v24, v20
    v_add_f32 v24, v24, v21
    v_add_f32 v24, v24, v22
    v_add_f32 v24, v24, v23
    s_nop 1
    v_add_f32_dpp v24, v24, v24 row_ror:8 row_mask:0xf bank_mask:0xf
    s_nop 1
    v_add_f32_dpp v24, v24, v24 row_ror:4 row_mask:0xf bank_mask:0xf
    s_nop 1
    v_add_f32_dpp v24, v24, v24 row_ror:2 row_mask:0xf bank_mask:0xf
    s_nop 1
    v_add_f32_dpp v24, v24, v24 row_ror:1 row_mask:0xf bank_mask:0xf
    s_nop 0
    v_mov_b32 v26, v24
    v_mov_b32 v27, v24
    s_nop 1
    v_permlane16_swap_b32 v26, v27
    s_nop 0
    v_add_f32 v24, v26, v27
    v_mov_b32 v26, v24
    v_mov_b32 v27, v24
    s_nop 1
    v_permlane32_swap_b32 v26, v27
    s_nop 0
    v_add_f32 v24, v26, v27
    v_mul_f32 v24, 0x3b000000, v24
    v_mov_b32 v25, 0
    v_sub_f32 v26, v16, v24
    v_fmac_f32 v25, v26, v26
    v_sub_f32 v26, v17, v24
    v_fmac_f32 v25, v26, v26
    v_sub_f32 v26, v18, v24
    v_fmac_f32 v25, v26, v26
    v_sub_f32 v26, v19, v24
    v_fmac_f32 v25, v26, v26
    v_sub_f32 v26, v20, v24
    v_fmac_f32 v25, v26, v26
    v_sub_f32 v26, v21, v24
    v_fmac_f32 v25, v26, v26
    v_sub_f32 v26, v22, v24
    v_fmac_f32 v25, v26, v26
    v_sub_f32 v26, v23, v24
    v_fmac_f32 v25, v26, v26
    s_nop 1
    v_add_f32_dpp v25, v25, v25 row_ror:8 row_mask:0xf bank_mask:0xf
    s_nop 1
    v_add_f32_dpp v25, v25, v25 row_ror:4 row_mask:0xf bank_mask:0xf
    s_nop 1
    v_add_f32_dpp v25, v25, v25 row_ror:2 row_mask:0xf bank_mask:0xf
    s_nop 1
    v_add_f32_dpp v25, v25, v25 row_ror:1 row_mask:0xf bank_mask:0xf
    s_nop 0
    v_mov_b32 v26, v25
    v_mov_b32 v27, v25
    s_nop 1
    v_permlane16_swap_b32 v26, v27
    s_nop 0
    v_add_f32 v25, v26, v27
    v_mov_b32 v26, v25
    v_mov_b32 v27, v25
    s_nop 1
    v_permlane32_swap_b32 v26, v27
    s_nop 0
    v_add_f32 v25, v26, v27
    v_mul_f32 v25, 0x3b000000, v25
    v_cvt_pk_bf16_f32 v26, v24, v25
    v_lshlrev_b32 v24, 16, v26
    v_and_b32 v25, 0xffff0000, v26
    v_add_f32 v25, 0x3727c5ac, v25
    v_cvt_pk_bf16_f32 v25, v25, v25
    v_and_b32 v25, 0xffff0000, v25
    v_sqrt_f32 v25, v25
    s_nop 0
    v_cvt_pk_bf16_f32 v25, v25, v25
    v_and_b32 v25, 0xffff0000, v25
    v_rcp_f32 v28, v25
    v_sub_f32 v16, v16, v24
    v_sub_f32 v17, v17, v24
    v_sub_f32 v18, v18, v24
    v_sub_f32 v19, v19, v24
    v_sub_f32 v20, v20, v24
    v_sub_f32 v21, v21, v24
    v_sub_f32 v22, v22, v24
    v_sub_f32 v23, v23, v24
    v_cvt_pk_bf16_f32 v26, v16, v17
    v_lshlrev_b32 v16, 16, v26
    v_and_b32 v17, 0xffff0000, v26
    v_cvt_pk_bf16_f32 v26, v18, v19
    v_lshlrev_b32 v18, 16, v26
    v_and_b32 v19, 0xffff0000, v26
    v_cvt_pk_bf16_f32 v26, v20, v21
    v_lshlrev_b32 v20, 16, v26
    v_and_b32 v21, 0xffff0000, v26
    v_cvt_pk_bf16_f32 v26, v22, v23
    v_lshlrev_b32 v22, 16, v26
    v_and_b32 v23, 0xffff0000, v26
    v_mul_f32 v26, v16, v28
    v_fma_f32 v27, -v26, v25, v16
    v_fma_f32 v16, v27, v28, v26
    v_mul_f32 v26, v17, v28
    v_fma_f32 v27, -v26, v25, v17
    v_fma_f32 v17, v27, v28, v26
    v_mul_f32 v26, v18, v28
    v_fma_f32 v27, -v26, v25, v18
    v_fma_f32 v18, v27, v28, v26
    v_mul_f32 v26, v19, v28
    v_fma_f32 v27, -v26, v25, v19
    v_fma_f32 v19, v27, v28, v26
    v_mul_f32 v26, v20, v28
    v_fma_f32 v27, -v26, v25, v20
    v_fma_f32 v20, v27, v28, v26
    v_mul_f32 v26, v21, v28
    v_fma_f32 v27, -v26, v25, v21
    v_fma_f32 v21, v27, v28, v26
    v_mul_f32 v26, v22, v28
    v_fma_f32 v27, -v26, v25, v22
    v_fma_f32 v22, v27, v28, v26
    v_mul_f32 v26, v23, v28
    v_fma_f32 v27, -v26, v25, v23
    v_fma_f32 v23, v27, v28, v26
    v_cvt_pk_bf16_f32 v8, v16, v17
    v_cvt_pk_bf16_f32 v9, v18, v19
    v_cvt_pk_bf16_f32 v10, v20, v21
    v_cvt_pk_bf16_f32 v11, v22, v23
    v_lshlrev_b32 v16, 16, v12
    v_and_b32 v17, 0xffff0000, v12
    v_lshlrev_b32 v18, 16, v13
    v_and_b32 v19, 0xffff0000, v13
    v_lshlrev_b32 v20, 16, v14
    v_and_b32 v21, 0xffff0000, v14
    v_lshlrev_b32 v22, 16, v15
    v_and_b32 v23, 0xffff0000, v15
    v_add_f32 v24, v16, v17
    v_add_f32 v24, v24, v18
    v_add_f32 v24, v24, v19
    v_add_f32 v24, v24, v20
    v_add_f32 v24, v24, v21
    v_add_f32 v24, v24, v22
    v_add_f32 v24, v24, v23
    s_nop 1
    v_add_f32_dpp v24, v24, v24 row_ror:8 row_mask:0xf bank_mask:0xf
    s_nop 1
    v_add_f32_dpp v24, v24, v24 row_ror:4 row_mask:0xf bank_mask:0xf
    s_nop 1
    v_add_f32_dpp v24, v24, v24 row_ror:2 row_mask:0xf bank_mask:0xf
    s_nop 1
    v_add_f32_dpp v24, v24, v24 row_ror:1 row_mask:0xf bank_mask:0xf
    s_nop 0
    v_mov_b32 v26, v24
    v_mov_b32 v27, v24
    s_nop 1
    v_permlane16_swap_b32 v26, v27
    s_nop 0
    v_add_f32 v24, v26, v27
    v_mov_b32 v26, v24
    v_mov_b32 v27, v24
    s_nop 1
    v_permlane32_swap_b32 v26, v27
    s_nop 0
    v_add_f32 v24, v26, v27
    v_mul_f32 v24, 0x3b000000, v24
    v_mov_b32 v25, 0
    v_sub_f32 v26, v16, v24
    v_fmac_f32 v25, v26, v26
    v_sub_f32 v26, v17, v24
    v_fmac_f32 v25, v26, v26
    v_sub_f32 v26, v18, v24
    v_fmac_f32 v25, v26, v26
    v_sub_f32 v26, v19, v24
    v_fmac_f32 v25, v26, v26
    v_sub_f32 v26, v20, v24
    v_fmac_f32 v25, v26, v26
    v_sub_f32 v26, v21, v24
    v_fmac_f32 v25, v26, v26
    v_sub_f32 v26, v22, v24
    v_fmac_f32 v25, v26, v26
    v_sub_f32 v26, v23, v24
    v_fmac_f32 v25, v26, v26
    s_nop 1
    v_add_f32_dpp v25, v25, v25 row_ror:8 row_mask:0xf bank_mask:0xf
    s_nop 1
    v_add_f32_dpp v25, v25, v25 row_ror:4 row_mask:0xf bank_mask:0xf
    s_nop 1
    v_add_f32_dpp v25, v25, v25 row_ror:2 row_mask:0xf bank_mask:0xf
    s_nop 1
    v_add_f32_dpp v25, v25, v25 row_ror:1 row_mask:0xf bank_mask:0xf
    s_nop 0
    v_mov_b32 v26, v25
    v_mov_b32 v27, v25
    s_nop 1
    v_permlane16_swap_b32 v26, v27
    s_nop 0
    v_add_f32 v25, v26, v27
    v_mov_b32 v26, v25
    v_mov_b32 v27, v25
    s_nop 1
    v_permlane32_swap_b32 v26, v27
    s_nop 0
    v_add_f32 v25, v26, v27
    v_mul_f32 v25, 0x3b000000, v25
    v_cvt_pk_bf16_f32 v26, v24, v25
    v_lshlrev_b32 v24, 16, v26
    v_and_b32 v25, 0xffff0000, v26
    v_add_f32 v25, 0x3727c5ac, v25
    v_cvt_pk_bf16_f32 v25, v25, v25
    v_and_b32 v25, 0xffff0000, v25
    v_sqrt_f32 v25, v25
    s_nop 0
    v_cvt_pk_bf16_f32 v25, v25, v25
    v_and_b32 v25, 0xffff0000, v25
    v_rcp_f32 v28, v25
    v_sub_f32 v16, v16, v24
    v_sub_f32 v17, v17, v24
    v_sub_f32 v18, v18, v24
    v_sub_f32 v19, v19, v24
    v_sub_f32 v20, v20, v24
    v_sub_f32 v21, v21, v24
    v_sub_f32 v22, v22, v24
    v_sub_f32 v23, v23, v24
    v_cvt_pk_bf16_f32 v26, v16, v17
    v_lshlrev_b32 v16, 16, v26
    v_and_b32 v17, 0xffff0000, v26
    v_cvt_pk_bf16_f32 v26, v18, v19
    v_lshlrev_b32 v18, 16, v26
    v_and_b32 v19, 0xffff0000, v26
    v_cvt_pk_bf16_f32 v26, v20, v21
    v_lshlrev_b32 v20, 16, v26
    v_and_b32 v21, 0xffff0000, v26
    v_cvt_pk_bf16_f32 v26, v22, v23
    v_lshlrev_b32 v22, 16, v26
    v_and_b32 v23, 0xffff0000, v26
    v_mul_f32 v26, v16, v28
    v_fma_f32 v27, -v26, v25, v16
    v_fma_f32 v16, v27, v28, v26
    v_mul_f32 v26, v17, v28
    v_fma_f32 v27, -v26, v25, v17
    v_fma_f32 v17, v27, v28, v26
    v_mul_f32 v26, v18, v28
    v_fma_f32 v27, -v26, v25, v18
    v_fma_f32 v18, v27, v28, v26
    v_mul_f32 v26, v19, v28
    v_fma_f32 v27, -v26, v25, v19
    v_fma_f32 v19, v27, v28, v26
    v_mul_f32 v26, v20, v28
    v_fma_f32 v27, -v26, v25, v20
    v_fma_f32 v20, v27, v28, v26
    v_mul_f32 v26, v21, v28
    v_fma_f32 v27, -v26, v25, v21
    v_fma_f32 v21, v27, v28, v26
    v_mul_f32 v26, v22, v28
    v_fma_f32 v27, -v26, v25, v22
    v_fma_f32 v22, v27, v28, v26
    v_mul_f32 v26, v23, v28
    v_fma_f32 v27, -v26, v25, v23
    v_fma_f32 v23, v27, v28, v26
    v_cvt_pk_bf16_f32 v12, v16, v17
    v_cvt_pk_bf16_f32 v13, v18, v19
    v_cvt_pk_bf16_f32 v14, v20, v21
    v_cvt_pk_bf16_f32 v15, v22, v23
    v_add_u32 v5, 157696, v4
    ds_write_b128 v5, v[8:11]
    ds_write_b128 v5, v[12:15] offset:1024
    s_waitcnt vmcnt(0) lgkmcnt(0)
    s_lshl_b32 s73, s35, 7
    s_add_u32 s73, s73, 157696
    v_lshrrev_b32 v5, 2, v3
    v_lshl_add_u32 v5, v2, 3, v5
    v_lshlrev_b32 v5, 7, v5
    v_and_b32 v6, 3, v3
    v_lshl_add_u32 v5, v6, 3, v5
    v_add_u32 v5, 147456, v5
    v_lshrrev_b32 v30, 3, v3
    v_lshlrev_b32 v30, 10, v30
    v_lshl_add_u32 v30, v2, 4, v30
    v_add_u32 v30, s73, v30
    ds_read_b128 v[48:51], v30 offset:0
    ds_read_b64_tr_b16 v[32:33], v5 offset:0
    ds_read_b64_tr_b16 v[34:35], v5 offset:512
    ds_read_b64_tr_b16 v[36:37], v5 offset:32
    ds_read_b64_tr_b16 v[38:39], v5 offset:544
    ds_read_b64_tr_b16 v[40:41], v5 offset:64
    ds_read_b64_tr_b16 v[42:43], v5 offset:576
    ds_read_b64_tr_b16 v[44:45], v5 offset:96
    ds_read_b64_tr_b16 v[46:47], v5 offset:608
    s_waitcnt lgkmcnt(6)
    v_mfma_f32_16x16x32_bf16 v[64:67], v[32:35], v[48:51], 0
    s_waitcnt lgkmcnt(4)
    v_mfma_f32_16x16x32_bf16 v[68:71], v[36:39], v[48:51], 0
    s_waitcnt lgkmcnt(2)
    v_mfma_f32_16x16x32_bf16 v[72:75], v[40:43], v[48:51], 0
    s_waitcnt lgkmcnt(0)
    v_mfma_f32_16x16x32_bf16 v[76:79], v[44:47], v[48:51], 0
    ds_read_b128 v[48:51], v30 offset:64
    ds_read_b64_tr_b16 v[32:33], v5 offset:4096
    ds_read_b64_tr_b16 v[34:35], v5 offset:4608
    ds_read_b64_tr_b16 v[36:37], v5 offset:4128
    ds_read_b64_tr_b16 v[38:39], v5 offset:4640
    ds_read_b64_tr_b16 v[40:41], v5 offset:4160
    ds_read_b64_tr_b16 v[42:43], v5 offset:4672
    ds_read_b64_tr_b16 v[44:45], v5 offset:4192
    ds_read_b64_tr_b16 v[46:47], v5 offset:4704
    s_waitcnt lgkmcnt(6)
    v_mfma_f32_16x16x32_bf16 v[64:67], v[32:35], v[48:51], v[64:67]
    s_waitcnt lgkmcnt(4)
    v_mfma_f32_16x16x32_bf16 v[68:71], v[36:39], v[48:51], v[68:71]
    s_waitcnt lgkmcnt(2)
    v_mfma_f32_16x16x32_bf16 v[72:75], v[40:43], v[48:51], v[72:75]
    s_waitcnt lgkmcnt(0)
    v_mfma_f32_16x16x32_bf16 v[76:79], v[44:47], v[48:51], v[76:79]
    s_nop 7
    s_nop 1
    v_and_b32 v6, 3, v3
    v_mov_b32 v16, v64
    v_mov_b32 v17, v65
    v_mov_b32 v18, v66
    v_mov_b32 v19, v67
    v_cmp_eq_u32 vcc, 1, v6
    s_nop 1
    v_cndmask_b32 v16, v16, v68, vcc
    v_cndmask_b32 v17, v17, v69, vcc
    v_cndmask_b32 v18, v18, v70, vcc
    v_cndmask_b32 v19, v19, v71, vcc
    v_cmp_eq_u32 vcc, 2, v6
    s_nop 1
    v_cndmask_b32 v16, v16, v72, vcc
    v_cndmask_b32 v17, v17, v73, vcc
    v_cndmask_b32 v18, v18, v74, vcc
    v_cndmask_b32 v19, v19, v75, vcc
    v_cmp_eq_u32 vcc, 3, v6
    s_nop 1
    v_cndmask_b32 v16, v16, v76, vcc
    v_cndmask_b32 v17, v17, v77, vcc
    v_cndmask_b32 v18, v18, v78, vcc
    v_cndmask_b32 v19, v19, v79, vcc
    v_mov_b32 v20, 0xffffff00
    v_add_u32 v16, 0x80, v16
    v_add_u32 v17, 0x80, v17
    v_add_u32 v18, 0x80, v18
    v_add_u32 v19, 0x80, v19
    v_and_or_b32 v16, v16, v20, s64
    v_and_or_b32 v17, v17, v20, s65
    v_and_or_b32 v18, v18, v20, s66
    v_and_or_b32 v19, v19, v20, s67
    v_lshlrev_b32 v7, 6, v6
    v_lshl_add_u32 v7, v2, 4, v7
    v_and_b32 v6, 4, v3
    v_cmp_eq_u32 vcc, 0, v6
    v_lshrrev_b32 v6, 3, v3
    v_lshl_add_u32 v7, v6, 8, v7
    s_lshl_b32 s69, s32, 12
    s_lshl_b32 s72, s35, 9
    s_add_u32 s69, s69, s72
    s_add_u32 s69, s69, 327680
    s_and_saveexec_b64 s[70:71], vcc
    buffer_store_dwordx4 v[16:19], v7, s[36:39], s69 offen sc1
    s_mov_b64 exec, s[70:71]
    v_and_b32 v5, 7, v3
    v_lshlrev_b32 v5, 9, v5
    v_lshrrev_b32 v6, 3, v3
    v_lshl_add_u32 v5, v6, 8, v5
    v_and_b32 v6, 1, v2
    v_lshl_add_u32 v5, v6, 4, v5
    s_lshr_b32 s72, s68, 3
    s_lshl_b32 s72, s72, 12
    s_and_b32 s73, s68, 7
    s_lshl_b32 s73, s73, 5
    s_add_u32 s72, s72, s73
    s_add_u32 s72, s72, 327680
    s_sleep 80
L_a2_h:
    buffer_load_dwordx4 v[64:67], v5, s[36:39], s72 offen sc1
    s_waitcnt vmcnt(0)
    v_xor_b32 v64, s64, v64
    v_xor_b32 v65, s65, v65
    v_xor_b32 v66, s66, v66
    v_xor_b32 v67, s67, v67
    v_or3_b32 v6, v64, v65, v66
    v_or_b32 v6, v6, v67
    v_and_b32 v6, 0xff, v6
    v_cmp_ne_u32 vcc, 0, v6
    s_cbranch_vccz L_a2_hd
    s_sleep 8
    s_branch L_a2_h
L_a2_hd:
    s_nop 0
    v_add_f32_dpp v64, v64, v64 quad_perm:[1,0,3,2] row_mask:0xf bank_mask:0xf
    v_add_f32_dpp v65, v65, v65 quad_perm:[1,0,3,2] row_mask:0xf bank_mask:0xf
    v_add_f32_dpp v66, v66, v66 quad_perm:[1,0,3,2] row_mask:0xf bank_mask:0xf
    v_add_f32_dpp v67, v67, v67 quad_perm:[1,0,3,2] row_mask:0xf bank_mask:0xf
    s_nop 0
    v_add_f32_dpp v64, v64, v64 quad_perm:[2,3,0,1] row_mask:0xf bank_mask:0xf
    v_add_f32_dpp v65, v65, v65 quad_perm:[2,3,0,1] row_mask:0xf bank_mask:0xf
    v_add_f32_dpp v66, v66, v66 quad_perm:[2,3,0,1] row_mask:0xf bank_mask:0xf
    v_add_f32_dpp v67, v67, v67 quad_perm:[2,3,0,1] row_mask:0xf bank_mask:0xf
    s_nop 0
    v_add_f32_dpp v64, v64, v64 row_half_mirror row_mask:0xf bank_mask:0xf
    v_add_f32_dpp v65, v65, v65 row_half_mirror row_mask:0xf bank_mask:0xf
    v_add_f32_dpp v66, v66, v66 row_half_mirror row_mask:0xf bank_mask:0xf
    v_add_f32_dpp v67, v67, v67 row_half_mirror row_mask:0xf bank_mask:0xf
    s_nop 0
    v_cvt_pk_bf16_f32 v68, v64, v65
    v_cvt_pk_bf16_f32 v69, v66, v67
    v_lshlrev_b32 v64, 16, v68
    v_and_b32 v65, 0xffff0000, v68
    v_lshlrev_b32 v66, 16, v69
    v_and_b32 v67, 0xffff0000, v69
    v_lshlrev_b32 v72, 16, v80
    v_and_b32 v73, 0xffff0000, v80
    v_lshlrev_b32 v74, 16, v81
    v_and_b32 v75, 0xffff0000, v81
    v_add_f32 v64, v64, v72
    v_add_f32 v65, v65, v73
    v_add_f32 v66, v66, v74
    v_add_f32 v67, v67, v75
    v_cvt_pk_bf16_f32 v68, v64, v65
    v_cvt_pk_bf16_f32 v69, v66, v67
    v_lshlrev_b32 v64, 16, v68
    v_and_b32 v65, 0xffff0000, v68
    v_lshlrev_b32 v66, 16, v69
    v_and_b32 v67, 0xffff0000, v69
    s_mov_b32 s72, 0x3d372713
    s_mov_b32 s73, 0xc0135761
    v_mul_f32 v72, v64, v64
    v_mul_f32 v72, v72, v64
    v_fma_f32 v72, v72, s72, v64
    v_mul_f32 v72, s73, v72
    v_exp_f32 v72, v72
    s_nop 0
    v_add_f32 v72, 1.0, v72
    v_rcp_f32 v72, v72
    s_nop 0
    v_mul_f32 v64, v64, v72
    v_mul_f32 v73, v65, v65
    v_mul_f32 v73, v73, v65
    v_fma_f32 v73, v73, s72, v65
    v_mul_f32 v73, s73, v73
    v_exp_f32 v73, v73
    s_nop 0
    v_add_f32 v73, 1.0, v73
    v_rcp_f32 v73, v73
    s_nop 0
    v_mul_f32 v65, v65, v73
    v_mul_f32 v74, v66, v66
    v_mul_f32 v74, v74, v66
    v_fma_f32 v74, v74, s72, v66
    v_mul_f32 v74, s73, v74
    v_exp_f32 v74, v74
    s_nop 0
    v_add_f32 v74, 1.0, v74
    v_rcp_f32 v74, v74
    s_nop 0
    v_mul_f32 v66, v66, v74
    v_mul_f32 v75, v67, v67
    v_mul_f32 v75, v75, v67
    v_fma_f32 v75, v75, s72, v67
    v_mul_f32 v75, s73, v75
    v_exp_f32 v75, v75
    s_nop 0
    v_add_f32 v75, 1.0, v75
    v_rcp_f32 v75, v75
    s_nop 0
    v_mul_f32 v67, v67, v75
    v_cvt_pk_bf16_f32 v68, v64, v65
    v_cvt_pk_bf16_f32 v69, v66, v67
    v_cmp_gt_u32 vcc, 2, v2
    s_nop 1
    v_cndmask_b32 v68, 0, v68, vcc
    v_cndmask_b32 v69, 0, v69, vcc
    v_lshlrev_b32 v5, 3, v0
    v_add_u32 v5, 160768, v5
    ds_write_b64 v5, v[68:69]
    s_waitcnt lgkmcnt(0)
    v_mov_b32 v5, 161540
    v_mov_b32 v6, 1
    ds_write_b32 v5, v6
    s_branch L_acommon
L_a2_skip:
    s_barrier
    s_load_dwordx2 s[80:81], s[28:29], 262144
    s_waitcnt lgkmcnt(0)
    s_add_u32 s82, s80, 1
    s_addc_u32 s83, s81, 0
    s_and_b32 s84, s82, 0xfff
    s_bfe_u32 s85, s82, 0xc000c
    s_lshr_b32 s86, s82, 24
    s_lshl_b32 s87, s83, 8
    s_or_b32 s86, s86, s87
    s_and_b32 s86, s86, 0xfff
    s_bfe_u32 s87, s83, 0xc0004
    s_and_b32 s64, s82, 0xff
    s_bfe_u32 s65, s82, 0x80008
    s_bfe_u32 s66, s82, 0x80010
    s_lshr_b32 s67, s82, 24
L_acommon:
    v_lshrrev_b32 v5, 3, v3
    v_lshlrev_b32 v5, 4, v5
    v_and_b32 v6, 7, v3
    v_add_u32 v5, v5, v6
    v_lshlrev_b32 v43, 7, v5
    v_lshl_add_u32 v42, v2, 4, v43
    s_lshl_b32 s72, s35, 17
    s_add_u32 s72, s72, 1048576
    s_lshl_b32 s74, s32, 12
    s_add_u32 s74, s74, s72
    s_add_u32 s78, s74, 1024
    v_and_b32 v6, 1, v2
    v_lshrrev_b32 v5, 1, v2
    v_lshlrev_b32 v5, 4, v5
    v_lshrrev_b32 v7, 2, v3
    v_add_u32 v5, v5, v7
    s_lshl_b32 s72, s30, 2
    v_add_u32 v5, s72, v5
    v_add_u32 v7, s2, v5
    v_and_b32 v7, 255, v7
    v_lshlrev_b32 v7, 7, v7
    v_lshl_add_u32 v5, v5, 15, v7
    v_and_b32 v7, 3, v3
    v_lshl_add_u32 v5, v7, 5, v5
    v_lshl_add_u32 v60, v6, 4, v5
    v_lshrrev_b32 v5, 15, v60
    v_lshlrev_b32 v5, 4, v5
    s_mov_b32 s73, 131072
    s_sleep 40
L_xt:
    buffer_load_dwordx4 v[44:47], v5, s[36:39], s73 offen sc1
    s_waitcnt vmcnt(0)
    v_xor_b32 v46, s82, v46
    v_xor_b32 v47, s83, v47
    v_or_b32 v46, v46, v47
    v_cmp_ne_u32 vcc, 0, v46
    s_cbranch_vccz L_xt_d
    s_sleep 16
    s_branch L_xt
L_xt_d:
    s_getreg_b32 s73, hwreg(HW_REG_XCC_ID)
    v_cmp_eq_u32 s[98:99], s73, v44
    v_mov_b32 v61, 0xfffff000
    v_lshlrev_b32 v62, 3, v0
    v_add_u32 v62, 161792, v62
    v_mov_b32 v63, 161552
    s_mov_b32 s76, 0x05040100
    s_mov_b32 s77, 0x07060302
    v_mov_b32 v40, 0
    v_mov_b32 v41, 0
    s_cmp_ge_u32 s32, 28
    s_cbranch_scc1 L_noh
    v_mov_b32 v5, 161540
L_ah:
    ds_read_b32 v6, v5
    s_waitcnt lgkmcnt(0)
    v_readfirstlane_b32 s75, v6
    s_cmp_eq_u32 s75, 0
    s_cbranch_scc0 L_ah_d
    s_sleep 4
    s_branch L_ah
L_ah_d:
    v_lshlrev_b32 v5, 3, v0
    v_add_u32 v5, 160768, v5
    ds_read_b64 v[40:41], v5
    s_waitcnt lgkmcnt(0)
L_noh:
    v_lshlrev_b32 v68, 12, v2
    v_lshl_add_u32 v68, v3, 4, v68
    s_lshl_b32 s72, s35, 9
    s_lshl_b32 s73, s32, 4
    s_add_u32 s72, s72, s73
    s_lshl_b32 s72, s72, 10
    s_lshl_b32 s73, s30, 8
    s_add_u32 s72, s72, s73
    v_and_b32 v6, 1, v2
    v_lshlrev_b32 v6, 12, v6
    v_lshl_add_u32 v69, v3, 4, v6
    s_min_u32 s79, s32, 27
    s_mul_i32 s75, s35, 28
    s_add_u32 s79, s79, s75
    s_lshl_b32 s79, s79, 13
    s_add_u32 s79, s79, s73
    v_mov_b32 v5, 161560
L_aw:
    ds_read_b32 v6, v5
    s_waitcnt lgkmcnt(0)
    v_readfirstlane_b32 s75, v6
    s_cmp_eq_u32 s75, 0
    s_cbranch_scc0 L_aw_d
    s_sleep 8
    s_branch L_aw
L_aw_d:
    buffer_load_dwordx4 v[92:95], v69, s[56:59], s79 offen offset:0 nt
    buffer_load_dwordx4 v[96:99], v69, s[56:59], s79 offen offset:1024 nt
    buffer_load_dwordx4 v[100:103], v69, s[56:59], s79 offen offset:2048 nt
    buffer_load_dwordx4 v[104:107], v69, s[56:59], s79 offen offset:3072 nt
    buffer_load_dwordx4 v[76:79], v68, s[52:55], s72 offen offset:0 nt
    buffer_load_dwordx4 v[80:83], v68, s[52:55], s72 offen offset:1024 nt
    buffer_load_dwordx4 v[84:87], v68, s[52:55], s72 offen offset:2048 nt
    buffer_load_dwordx4 v[88:91], v68, s[52:55], s72 offen offset:3072 nt
    s_mov_b32 s72, 2097152
    s_barrier
    s_cmp_eq_u32 s30, 0
    s_cbranch_scc0 L_nop1
    buffer_load_dwordx4 v[44:47], v42, s[36:39], s74 offen sc1
    buffer_load_dwordx4 v[48:51], v42, s[36:39], s78 offen sc1
    buffer_load_dwordx4 v[52:55], v43, s[36:39], s74 offen offset:64 sc1
    buffer_load_dwordx4 v[64:67], v43, s[36:39], s78 offen offset:64 sc1
    s_waitcnt vmcnt(8)
    s_branch L_w2go
L_nop1:
    s_waitcnt vmcnt(4)
L_w2go:
    v_perm_b32 v124, v96, v92, s76
    v_perm_b32 v125, v104, v100, s76
    v_perm_b32 v126, v96, v92, s77
    v_perm_b32 v127, v104, v100, s77
    v_perm_b32 v128, v97, v93, s76
    v_perm_b32 v129, v105, v101, s76
    v_perm_b32 v130, v97, v93, s77
    v_perm_b32 v131, v105, v101, s77
    v_perm_b32 v132, v98, v94, s76
    v_perm_b32 v133, v106, v102, s76
    v_perm_b32 v134, v98, v94, s77
    v_perm_b32 v135, v106, v102, s77
    v_perm_b32 v136, v99, v95, s76
    v_perm_b32 v137, v107, v103, s76
    v_perm_b32 v138, v99, v95, s77
    v_perm_b32 v139, v107, v103, s77
    s_nop 1
    v_mfma_f32_16x16x16_bf16 v[8:11], v[40:41], v[124:125], 0
    v_mfma_f32_16x16x16_bf16 v[12:15], v[40:41], v[126:127], 0
    v_mfma_f32_16x16x16_bf16 v[16:19], v[40:41], v[128:129], 0
    v_mfma_f32_16x16x16_bf16 v[20:23], v[40:41], v[130:131], 0
    v_mfma_f32_16x16x16_bf16 v[24:27], v[40:41], v[132:133], 0
    v_mfma_f32_16x16x16_bf16 v[28:31], v[40:41], v[134:135], 0
    v_mfma_f32_16x16x16_bf16 v[32:35], v[40:41], v[136:137], 0
    v_mfma_f32_16x16x16_bf16 v[36:39], v[40:41], v[138:139], 0
    s_cmp_eq_u32 s30, 0
    s_cbranch_scc0 L_nop2
    s_waitcnt vmcnt(4)
    s_branch L_wogo
L_nop2:
    s_waitcnt vmcnt(0)
L_wogo:
    v_perm_b32 v108, v80, v76, s76
    v_perm_b32 v109, v88, v84, s76
    v_perm_b32 v110, v80, v76, s77
    v_perm_b32 v111, v88, v84, s77
    v_perm_b32 v112, v81, v77, s76
    v_perm_b32 v113, v89, v85, s76
    v_perm_b32 v114, v81, v77, s77
    v_perm_b32 v115, v89, v85, s77
    v_perm_b32 v116, v82, v78, s76
    v_perm_b32 v117, v90, v86, s76
    v_perm_b32 v118, v82, v78, s77
    v_perm_b32 v119, v90, v86, s77
    v_perm_b32 v120, v83, v79, s76
    v_perm_b32 v121, v91, v87, s76
    v_perm_b32 v122, v83, v79, s77
    v_perm_b32 v123, v91, v87, s77
    s_cmp_eq_u32 s30, 0
    s_cbranch_scc0 L_l1_wait
    s_branch L_l1_chk
L_l1:
    buffer_load_dwordx4 v[44:47], v42, s[36:39], s74 offen sc1
    buffer_load_dwordx4 v[48:51], v42, s[36:39], s78 offen sc1
    buffer_load_dwordx4 v[52:55], v43, s[36:39], s74 offen offset:64 sc1
    buffer_load_dwordx4 v[64:67], v43, s[36:39], s78 offen offset:64 sc1
L_l1_chk:
    s_waitcnt vmcnt(0)
    v_xor_b32 v44, s84, v44
    v_xor_b32 v48, s84, v48
    v_xor_b32 v52, s84, v52
    v_xor_b32 v64, s84, v64
    v_xor_b32 v45, s85, v45
    v_xor_b32 v49, s85, v49
    v_xor_b32 v53, s85, v53
    v_xor_b32 v65, s85, v65
    v_xor_b32 v46, s86, v46
    v_xor_b32 v50, s86, v50
    v_xor_b32 v54, s86, v54
    v_xor_b32 v66, s86, v66
    v_xor_b32 v47, s87, v47
    v_xor_b32 v51, s87, v51
    v_xor_b32 v55, s87, v55
    v_xor_b32 v67, s87, v67
    v_or3_b32 v6, v44, v45, v46
    v_or3_b32 v6, v6, v47, v48
    v_or3_b32 v6, v6, v49, v50
    v_or3_b32 v6, v6, v51, v52
    v_or3_b32 v6, v6, v53, v54
    v_or3_b32 v6, v6, v55, v64
    v_or3_b32 v6, v6, v65, v66
    v_or_b32 v6, v6, v67
    v_and_b32 v6, 0xfff, v6
    v_cmp_ne_u32 vcc, 0, v6
    s_cbranch_vccz L_l1_done
    s_sleep 1
    s_branch L_l1
L_l1_done:
    v_max_f32 v56, v52, v64
    s_nop 1
    v_max_f32_dpp v56, v56, v56 quad_perm:[1,0,3,2] row_mask:0xf bank_mask:0xf
    s_nop 1
    v_max_f32_dpp v56, v56, v56 quad_perm:[2,3,0,1] row_mask:0xf bank_mask:0xf
    s_nop 1
    v_max_f32_dpp v56, v56, v56 row_half_mirror row_mask:0xf bank_mask:0xf
    v_sub_f32 v52, v52, v56
    v_sub_f32 v64, v64, v56
    v_exp_f32 v52, v52
    v_exp_f32 v64, v64
    s_nop 0
    v_mul_f32 v57, v52, v53
    v_fmac_f32 v57, v64, v65
    v_mul_f32 v44, v44, v52
    v_fmac_f32 v44, v48, v64
    v_mul_f32 v45, v45, v52
    v_fmac_f32 v45, v49, v64
    v_mul_f32 v46, v46, v52
    v_fmac_f32 v46, v50, v64
    v_mul_f32 v47, v47, v52
    v_fmac_f32 v47, v51, v64
    s_nop 0
    v_add_f32_dpp v57, v57, v57 quad_perm:[1,0,3,2] row_mask:0xf bank_mask:0xf
    v_add_f32_dpp v44, v44, v44 quad_perm:[1,0,3,2] row_mask:0xf bank_mask:0xf
    v_add_f32_dpp v45, v45, v45 quad_perm:[1,0,3,2] row_mask:0xf bank_mask:0xf
    v_add_f32_dpp v46, v46, v46 quad_perm:[1,0,3,2] row_mask:0xf bank_mask:0xf
    v_add_f32_dpp v47, v47, v47 quad_perm:[1,0,3,2] row_mask:0xf bank_mask:0xf
    s_nop 0
    v_add_f32_dpp v57, v57, v57 quad_perm:[2,3,0,1] row_mask:0xf bank_mask:0xf
    v_add_f32_dpp v44, v44, v44 quad_perm:[2,3,0,1] row_mask:0xf bank_mask:0xf
    v_add_f32_dpp v45, v45, v45 quad_perm:[2,3,0,1] row_mask:0xf bank_mask:0xf
    v_add_f32_dpp v46, v46, v46 quad_perm:[2,3,0,1] row_mask:0xf bank_mask:0xf
    v_add_f32_dpp v47, v47, v47 quad_perm:[2,3,0,1] row_mask:0xf bank_mask:0xf
    s_nop 0
    v_add_f32_dpp v57, v57, v57 row_half_mirror row_mask:0xf bank_mask:0xf
    v_add_f32_dpp v44, v44, v44 row_half_mirror row_mask:0xf bank_mask:0xf
    v_add_f32_dpp v45, v45, v45 row_half_mirror row_mask:0xf bank_mask:0xf
    v_add_f32_dpp v46, v46, v46 row_half_mirror row_mask:0xf bank_mask:0xf
    v_add_f32_dpp v47, v47, v47 row_half_mirror row_mask:0xf bank_mask:0xf
    s_nop 0
    v_rcp_f32 v57, v57
    s_nop 0
    v_mul_f32 v44, v44, v57
    v_mul_f32 v45, v45, v57
    v_mul_f32 v46, v46, v57
    v_mul_f32 v47, v47, v57
    v_cvt_pk_bf16_f32 v58, v44, v45
    v_cvt_pk_bf16_f32 v59, v46, v47
    ds_write_b64 v62, v[58:59]
    v_mov_b32 v6, 1
    ds_write_b32 v63, v6
    s_branch L_l1_go
L_l1_wait:
    ds_read_b32 v6, v63
    ds_read_b64 v[58:59], v62
    s_waitcnt lgkmcnt(0)
    v_readfirstlane_b32 s75, v6
    s_cmp_eq_u32 s75, 0
    s_cbranch_scc1 L_l1_wait
L_l1_go:
    s_nop 1
    v_mfma_f32_16x16x16_bf16 v[8:11], v[58:59], v[108:109], v[8:11]
    v_mfma_f32_16x16x16_bf16 v[12:15], v[58:59], v[110:111], v[12:15]
    v_mfma_f32_16x16x16_bf16 v[16:19], v[58:59], v[112:113], v[16:19]
    v_mfma_f32_16x16x16_bf16 v[20:23], v[58:59], v[114:115], v[20:23]
    v_mfma_f32_16x16x16_bf16 v[24:27], v[58:59], v[116:117], v[24:27]
    v_mfma_f32_16x16x16_bf16 v[28:31], v[58:59], v[118:119], v[28:31]
    v_mfma_f32_16x16x16_bf16 v[32:35], v[58:59], v[120:121], v[32:35]
    v_mfma_f32_16x16x16_bf16 v[36:39], v[58:59], v[122:123], v[36:39]
    v_and_b32 v6, 1, v2
    v_cmp_eq_u32 vcc, 1, v6
    s_nop 7
    v_cndmask_b32 v44, v8, v24, vcc
    v_cndmask_b32 v45, v12, v28, vcc
    v_cndmask_b32 v46, v16, v32, vcc
    v_cndmask_b32 v47, v20, v36, vcc
    v_and_or_b32 v44, v44, v61, s84
    v_and_or_b32 v45, v45, v61, s85
    v_and_or_b32 v46, v46, v61, s86
    v_and_or_b32 v47, v47, v61, s87
    s_andn2_b64 exec, exec, s[98:99]
    buffer_store_dwordx4 v[44:47], v60, s[36:39], s72 offen sc1
    s_mov_b64 exec, s[98:99]
    buffer_store_dwordx4 v[44:47], v60, s[36:39], s72 offen
    s_mov_b64 exec, -1
    v_mov_b32 v5, 161556
    v_mov_b32 v6, 1
    ds_write_b32 v5, v6
    s_add_u32 s30, s30, 8
L_fin:
L_end:
    s_endpgm
.section .rodata,"a"
.p2align 6
.amdhsa_kernel parallel_sum__gqa_block_cached__dense_activation_gelu__decode_kernel
  .amdhsa_next_free_vgpr 168
  .amdhsa_next_free_sgpr 102
  .amdhsa_accum_offset 168
  .amdhsa_group_segment_fixed_size 0
  .amdhsa_kernarg_size 104
  .amdhsa_user_sgpr_count 2
  .amdhsa_user_sgpr_kernarg_segment_ptr 1
  .amdhsa_system_sgpr_workgroup_id_x 1
.end_amdhsa_kernel
```
